```python
import torch

def _softmax(x, axis=-1):
    return torch.softmax(x, dim=axis)
def _gelu(x):
    return torch.nn.functional.gelu(x, approximate="tanh")
def _silu(x):
    return torch.nn.functional.silu(x)
def _sigmoid(x):
    return torch.sigmoid(x)
def _layernorm(x, axis=-1, eps=1e-5):
    m = x.mean(dim=axis, keepdim=True)
    v = x.var(dim=axis, keepdim=True, unbiased=False)
    return (x - m) / torch.sqrt(v + eps)
def _scatter_add(tgt, idx, src, axis=0):
    return tgt.clone().index_add_(axis, idx, src)
def _segment_sum(src, seg, n):
    out = torch.zeros((n,) + src.shape[1:], dtype=src.dtype)
    return out.index_add_(0, seg, src)
def _pad(x, pw):
    flat = tuple(v for pair in reversed(pw) for v in pair)
    return torch.nn.functional.pad(x, flat)

kernel_name = 'standalone__edge_featured_mpnn_gatedgcn__graph'

def setup_inputs():

    _w = (lambda a: (lambda t: t.to(torch.bfloat16) if t.is_floating_point() else t)(torch.as_tensor(a)))
    N, deg, D, De = 10000, 16, 128, max(4, 1)
    E = N * deg
    return {
        "x": _w((lambda *s: torch.randn(*s, dtype=torch.bfloat16) * 0.4)(N, D)),
        "e_attr": _w((lambda *s: torch.randn(*s, dtype=torch.bfloat16) * 0.8)(E, De)),
        "src": _w((lambda lo, hi, *s: torch.randint(lo, hi, s))(0, N, E).to(torch.int64)),
        "dst": _w((lambda lo, hi, *s: torch.randint(lo, hi, s))(0, N, E).to(torch.int64)),
        "w_a": _w((lambda *s: torch.randn(*s, dtype=torch.bfloat16) * 0.4)(D, D)),
        "w_b": _w((lambda *s: torch.randn(*s, dtype=torch.bfloat16) * 0.4)(D, D)),
        "w_c": _w((lambda *s: torch.randn(*s, dtype=torch.bfloat16) * 0.8)(De, D)),
        "w_u": _w((lambda *s: torch.randn(*s, dtype=torch.bfloat16) * 0.05)(D, D)),
        "w_v": _w((lambda *s: torch.randn(*s, dtype=torch.bfloat16) * 0.05)(D, D)),
    }

def reference(x, e_attr, src, dst, w_a, w_b, w_c, w_u, w_v):
    N, D = x.shape
    hv = x @ w_v
    g = x[dst] @ w_a + x[src] @ w_b + e_attr @ w_c
    eta = _sigmoid(g)
    denom = _segment_sum(eta, dst, N) + 1e-6
    eta_n = eta / denom[dst]
    agg = _segment_sum(eta_n * hv[src], dst, N)
    z = x @ w_u + agg
    relu_z = torch.where(z > 0, z, 0 * z)
    return x + relu_z
```

```asm
; @launch grid=(256,1,1) block=(1024,1,1) lds=155648
.amdgcn_target "amdgcn-amd-amdhsa--gfx950"
.text
.globl standalone__edge_featured_mpnn_gatedgcn__graph_kernel
.p2align 8
.type standalone__edge_featured_mpnn_gatedgcn__graph_kernel,@function
standalone__edge_featured_mpnn_gatedgcn__graph_kernel:
    s_cmp_ge_u32 s2, 256
    s_cbranch_scc1 L_end
    s_load_dwordx16 s[4:19], s[0:1], 0
    s_load_dwordx4 s[20:23], s[0:1], 64
    s_load_dwordx2 s[24:25], s[0:1], 88
    v_lshrrev_b32 v2, 6, v0
    v_and_b32 v1, 63, v0
    v_readfirstlane_b32 s26, v2
    s_and_b32 s27, s2, 3
    s_lshl_b32 s28, s2, 3
    s_and_b32 s28, s28, 32
    s_lshr_b32 s57, s2, 3
    s_add_u32 s28, s28, s57
    s_mul_i32 s57, s28, 625
    s_add_u32 s29, s57, 3
    s_lshr_b32 s29, s29, 2
    s_add_u32 s57, s57, 628
    s_lshr_b32 s57, s57, 2
    s_sub_u32 s30, s57, s29
    s_mov_b32 s31, 0x200000
    s_mov_b32 s75, 8028160
    s_cmp_ge_u32 s26, 5
    s_cbranch_scc1 L_QG
    s_mul_i32 s57, s2, 625
    s_add_u32 s57, s57, 1
    s_lshr_b32 s57, s57, 1
    s_and_b32 s58, s2, 1
    s_sub_u32 s58, 313, s58
    v_add_u32 v2, s57, v0
    v_cmp_gt_u32 s[62:63], s58, v0
    v_lshlrev_b32 v3, 4, v2
    v_lshlrev_b32 v2, 3, v2
    s_setprio 2
    v_and_b32 v56, 15, v1
    v_lshlrev_b32 v57, 18, v56
    v_or_b32 v57, 0x8003ffff, v57
    v_lshlrev_b32 v56, 4, v56
    s_mul_i32 s72, s26, 0x110
    s_and_b32 s72, s72, 0x3c0
    v_and_or_b32 v58, v1, 48, s72
    v_mov_b32 v59, 2
    v_mov_b32 v60, 0
    v_mov_b32 v61, 1
    v_mov_b32 v63, 0
    s_mov_b32 s80, 0
    s_movk_i32 s72, 0x3fc
    s_movk_i32 s73, 12798
    s_mov_b32 s74, 0x3ffff
    s_waitcnt lgkmcnt(0)
    s_mov_b64 exec, s[62:63]
    global_load_dwordx2 v[4:5], v2, s[10:11] nt
    s_load_dword s52, s[24:25], s75
    global_load_dwordx2 v[6:7], v2, s[8:9] nt
    global_load_dwordx4 v[8:11], v3, s[6:7] nt
    s_mov_b64 exec, -1
    s_add_u32 s44, s24, 7864320
    s_addc_u32 s45, s25, 0
    s_mov_b32 s46, 131072
    s_mov_b32 s47, 0x00020000
    s_add_u32 s48, s24, 5242880
    s_addc_u32 s49, s25, 0
    s_mov_b32 s50, 2621440
    s_mov_b32 s51, 0x00020000
    s_and_b32 s57, s26, 1
    s_lshl_b32 s57, s57, 8
    s_add_u32 s57, s57, s27
    s_lshl_b32 s57, s57, 6
    v_lshrrev_b32 v2, 4, v1
    v_and_b32 v2, 2, v2
    v_xor_b32 v2, v2, v1
    v_and_b32 v2, 3, v2
    v_lshl_add_u32 v2, v2, 4, s57
    v_lshrrev_b32 v3, 2, v1
    v_lshl_add_u32 v32, v3, 8, v2
    v_add_u32 v33, 3072, v32
    v_add_u32 v34, 6144, v32
    v_add_u32 v35, 9216, v32
    v_lshlrev_b32 v12, 2, v1
    v_lshlrev_b32 v28, 11, v1
    v_lshlrev_b32 v29, 3, v0
    s_lshl_b32 s57, s26, 4
    s_bfm_b64 s[64:65], 16, s57
    s_mul_i32 s66, s2, 640
    s_bitset1_b32 s66, 31
    s_lshl_b32 s67, s2, 3
    s_mov_b32 s57, 429497
    s_movk_i32 s58, 625
    s_mov_b32 s59, 112640
    s_waitcnt lgkmcnt(0)
    s_barrier
    s_mul_i32 s52, s52, 0x0019660d
    s_add_u32 s52, s52, 0x3c6ef35f
    v_mov_b32 v17, s52
    v_mov_b32 v19, s52
    v_mov_b32 v27, s52
    s_mov_b64 exec, s[62:63]
    s_waitcnt vmcnt(2)
    v_mul_u32_u24 v16, s57, v4
    v_mul_u32_u24 v18, s57, v5
    v_lshrrev_b32 v16, 26, v16
    v_lshrrev_b32 v18, 26, v18
    v_lshlrev_b32 v13, 2, v16
    v_lshlrev_b32 v14, 2, v18
    ds_add_rtn_u32 v15, v13, v61 offset:256
    ds_add_rtn_u32 v20, v14, v61 offset:256
    s_mov_b64 exec, 1
    ds_add_u32 v60, v61 offset:16
    s_mov_b64 exec, -1
    ds_read_b32 v21, v60 offset:16
    ds_read_b32 v22, v12 offset:256
    v_mad_u32_u24 v16, v16, s58, 3
    v_mad_u32_u24 v18, v18, s58, 3
    v_lshrrev_b32 v16, 2, v16
    v_lshrrev_b32 v18, 2, v18
    v_sub_u32 v16, v4, v16
    v_sub_u32 v18, v5, v18
    s_branch L_E1_w
L_E1:
    ds_read_b32 v21, v60 offset:16
    ds_read_b32 v22, v12 offset:256
L_E1_w:
    s_waitcnt lgkmcnt(0)
    v_cmp_ne_u32 vcc, 5, v21
    s_cbranch_vccz L_E1_d
    s_sub_u32 s31, s31, 1
    s_cbranch_scc0 L_E1
    s_endpgm
L_E1_d:
    v_add_u32_dpp v23, v22, v22 row_shr:1 row_mask:0xf bank_mask:0xf bound_ctrl:0
    s_nop 1
    v_add_u32_dpp v23, v23, v23 row_shr:2 row_mask:0xf bank_mask:0xf bound_ctrl:0
    s_nop 1
    v_add_u32_dpp v23, v23, v23 row_shr:4 row_mask:0xf bank_mask:0xf bound_ctrl:0
    s_nop 1
    v_add_u32_dpp v23, v23, v23 row_shr:8 row_mask:0xf bank_mask:0xf bound_ctrl:0
    s_nop 1
    v_add_u32_dpp v23, v23, v23 row_bcast:15 row_mask:0xa bank_mask:0xf
    s_nop 1
    v_add_u32_dpp v23, v23, v23 row_bcast:31 row_mask:0xc bank_mask:0xf
    v_sub_u32 v23, v23, v22
    v_lshl_add_u32 v21, v23, 4, s59
    v_lshl_add_u32 v26, v22, 18, v23
    ds_bpermute_b32 v24, v13, v21
    ds_bpermute_b32 v25, v14, v21
    v_add_u32 v26, s66, v26
    s_cmp_eq_u32 s26, 4
    s_waitcnt vmcnt(0)
    s_cbranch_scc1 L_E2
    s_mov_b64 exec, s[64:65]
    buffer_store_dwordx2 v[26:27], v28, s[44:47], s67 offen sc1
L_E2:
    s_mov_b64 exec, s[62:63]
    v_lshl_or_b32 v16, v16, 18, v6
    v_lshl_or_b32 v18, v18, 18, v7
    s_waitcnt lgkmcnt(0)
    v_lshl_add_u32 v24, v15, 4, v24
    v_lshl_add_u32 v25, v20, 4, v25
    ds_write2_b64 v24, v[8:9], v[16:17] offset1:1
    ds_write2_b64 v25, v[10:11], v[18:19] offset1:1
    s_mov_b64 exec, 1
    ds_add_u32 v60, v61 offset:0
    s_mov_b64 exec, -1
    s_cbranch_scc0 L_O
L_PQ:
    ds_read_b32 v4, v60 offset:0
    s_mul_i32 s57, s26, 5120
    v_lshlrev_b32 v2, 4, v1
    s_add_u32 s58, s57, 92160
    v_add_u32 v3, s58, v2
    s_mul_i32 s58, s2, 10240
    s_add_u32 s57, s57, s58
    s_sub_u32 s58, s57, 16384
    s_sub_u32 s57, s57, 20480
    s_branch L_P1_w
L_P1:
    ds_read_b32 v4, v60 offset:0
L_P1_w:
    s_waitcnt lgkmcnt(0)
    v_cmp_ne_u32 vcc, 5, v4
    s_cbranch_vccz L_P1_d
    s_sub_u32 s31, s31, 1
    s_cbranch_scc0 L_P1
    s_endpgm
L_P1_d:
    ds_read_b128 v[32:35], v3 offset:0
    ds_read_b128 v[36:39], v3 offset:1024
    ds_read_b128 v[40:43], v3 offset:2048
    ds_read_b128 v[44:47], v3 offset:3072
    ds_read_b128 v[48:51], v3 offset:4096
    s_waitcnt lgkmcnt(4)
    buffer_store_dwordx4 v[32:35], v2, s[48:51], s57 offen offset:0 sc1
    s_waitcnt lgkmcnt(3)
    buffer_store_dwordx4 v[36:39], v2, s[48:51], s57 offen offset:1024 sc1
    s_waitcnt lgkmcnt(2)
    buffer_store_dwordx4 v[40:43], v2, s[48:51], s57 offen offset:2048 sc1
    s_waitcnt lgkmcnt(1)
    buffer_store_dwordx4 v[44:47], v2, s[48:51], s57 offen offset:3072 sc1
    s_waitcnt lgkmcnt(0)
    buffer_store_dwordx4 v[48:51], v2, s[48:51], s58 offen offset:0 sc1
    s_mov_b64 exec, 1
    ds_add_u32 v60, v61 offset:4
    s_mov_b64 exec, -1
    s_branch L_D
L_QG:
    s_cmp_lg_u32 s26, 5
    s_cbranch_scc1 L_G
    v_mov_b32 v4, 0
    v_mov_b32 v5, 0
    v_mov_b32 v6, 0
    v_mov_b32 v7, 0
    v_lshlrev_b32 v2, 4, v1
    ds_write_b128 v2, v[4:7]
    ds_write_b128 v2, v[4:7] offset:6144
    v_lshlrev_b32 v64, 2, v1
    v_mul_u32_u24 v91, 80, v1
    v_add_u32 v92, 5120, v91
    v_add_u32 v93, 10240, v91
    ds_write_b32 v64, v91 offset:1792
    ds_write_b32 v64, v92 offset:2048
    ds_write_b32 v64, v93 offset:2304
    v_and_b32 v8, 31, v1
    s_lshl_b32 s57, s27, 6
    v_lshl_add_u32 v8, v8, 1, s57
    s_setprio 2
    s_waitcnt lgkmcnt(0)
    s_load_dword s52, s[24:25], s75
    global_load_ushort v12, v8, s[16:17]
    global_load_ushort v13, v8, s[16:17] offset:256
    global_load_ushort v14, v8, s[16:17] offset:512
    global_load_ushort v15, v8, s[16:17] offset:768
    s_add_u32 s48, s24, 5242880
    s_addc_u32 s49, s25, 0
    s_mov_b32 s50, 2621440
    s_mov_b32 s51, 0x00020000
    v_and_b32 v56, 15, v1
    v_lshlrev_b32 v57, 18, v56
    v_or_b32 v57, 0x8003ffff, v57
    v_lshlrev_b32 v56, 4, v56
    s_mul_i32 s72, s26, 0x110
    s_and_b32 s72, s72, 0x3c0
    v_and_or_b32 v58, v1, 48, s72
    v_mov_b32 v59, 2
    v_mov_b32 v60, 0
    v_mov_b32 v61, 1
    v_mov_b32 v63, 0
    s_mov_b32 s80, 0
    s_movk_i32 s72, 0x3fc
    s_movk_i32 s73, 12798
    s_mov_b32 s74, 0x3ffff
    v_and_b32 v3, 15, v1
    v_lshlrev_b32 v3, 4, v3
    v_lshl_add_u32 v70, v1, 8, v3
    v_add_u32 v68, 7168, v91
    v_lshlrev_b32 v71, 2, v91
    v_add_u32 v71, 60928, v71
    v_add_u32 v72, 7168, v92
    v_add_u32 v74, 16384, v70
    v_lshlrev_b32 v75, 2, v92
    v_add_u32 v75, 60928, v75
    v_add_u32 v76, 7168, v93
    v_add_u32 v78, 32768, v70
    v_lshlrev_b32 v79, 2, v93
    v_add_u32 v79, 60928, v79
    v_lshlrev_b32 v3, 3, v1
    s_waitcnt lgkmcnt(0)
    s_barrier
    s_mul_i32 s52, s52, 0x0019660d
    s_add_u32 s52, s52, 0x3c6ef35f
    s_waitcnt vmcnt(0)
    v_lshlrev_b32 v12, 16, v12
    v_lshlrev_b32 v13, 16, v13
    v_lshlrev_b32 v14, 16, v14
    v_lshlrev_b32 v15, 16, v15
    v_mul_f32 v12, 0xbfb8aa3b, v12
    v_mul_f32 v13, 0xbfb8aa3b, v13
    v_mul_f32 v14, 0xbfb8aa3b, v14
    v_mul_f32 v15, 0xbfb8aa3b, v15
    v_cvt_pk_bf16_f32 v12, v12, v13
    v_cvt_pk_bf16_f32 v13, v14, v15
    ds_write_b64 v3, v[12:13] offset:2560
    s_branch L_PQ
L_G:
    s_sub_u32 s64, s26, 6
    s_mul_i32 s57, s28, 0
    s_add_u32 s57, s57, 0x27102710
    v_mov_b32 v36, s57
    v_mov_b32 v37, s57
    v_mov_b32 v38, s57
    v_mov_b32 v39, s57
    v_lshlrev_b32 v15, 4, v1
    s_mul_i32 s57, s64, 1280
    v_add_u32 v26, s57, v15
    v_lshl_add_u32 v27, v1, 2, s57
    ds_write_b128 v26, v[36:39] offset:7168
    ds_write_b32 v27, v36 offset:8192
    v_mov_b32 v32, 0
    v_mov_b32 v33, 0
    v_mov_b32 v34, 0
    v_mov_b32 v35, 0
    s_mul_i32 s57, s64, 5120
    v_add_u32 v26, s57, v15
    ds_write_b128 v26, v[32:35] offset:60928
    ds_write_b128 v26, v[32:35] offset:61952
    ds_write_b128 v26, v[32:35] offset:62976
    ds_write_b128 v26, v[32:35] offset:64000
    ds_write_b128 v26, v[32:35] offset:65024
    v_lshrrev_b32 v28, 4, v1
    v_xor_b32 v29, v28, v1
    v_and_b32 v29, 15, v29
    v_lshlrev_b32 v29, 4, v29
    v_lshl_add_u32 v2, v28, 8, v29
    v_xor_b32 v3, 64, v2
    v_xor_b32 v4, 0x80, v2
    v_xor_b32 v5, 0xc0, v2
    s_lshl_b32 s65, s64, 12
    s_add_u32 s67, s65, 19968
    s_add_u32 m0, s65, 122880
    s_and_b32 s57, s64, 1
    s_lshl_b32 s57, s57, 8
    s_add_u32 s57, s57, s27
    s_lshl_b32 s57, s57, 6
    v_lshrrev_b32 v6, 4, v1
    v_and_b32 v6, 2, v6
    v_xor_b32 v6, v6, v1
    v_and_b32 v6, 3, v6
    v_lshl_add_u32 v6, v6, 4, s57
    v_lshrrev_b32 v7, 2, v1
    v_lshl_add_u32 v40, v7, 8, v6
    v_add_u32 v41, 3072, v40
    v_add_u32 v42, 6144, v40
    v_add_u32 v43, 9216, v40
    s_waitcnt lgkmcnt(0)
    s_load_dword s52, s[24:25], s75
    s_cmp_ge_u32 s64, 4
    s_cbranch_scc1 L_G0
    s_bitcmp0_b32 s64, 1
    s_cselect_b64 s[68:69], s[14:15], s[20:21]
    global_load_lds_dwordx4 v40, s[68:69] offset:0
    global_load_lds_dwordx4 v41, s[68:69] offset:1024
    global_load_lds_dwordx4 v42, s[68:69] offset:2048
    global_load_lds_dwordx4 v43, s[68:69] offset:3072
L_G0:
    s_lshl_b32 s57, s29, 8
    s_add_u32 s40, s4, s57
    s_addc_u32 s41, s5, 0
    s_sub_u32 s42, 2560000, s57
    s_mov_b32 s43, 0x00020000
    s_cmp_ge_u32 s64, 4
    s_cbranch_scc1 L_G1
    s_mov_b32 m0, s67
    s_nop 0
    buffer_load_dwordx4 v2, s[40:43], s65 offen offset:0 lds
    buffer_load_dwordx4 v3, s[40:43], s65 offen offset:1024 lds
    buffer_load_dwordx4 v4, s[40:43], s65 offen offset:2048 lds
    buffer_load_dwordx4 v5, s[40:43], s65 offen offset:3072 lds
L_G1:
    v_and_b32 v30, 15, v1
    v_lshl_add_u32 v12, v30, 8, v29
    v_add_u32 v12, s67, v12
    v_xor_b32 v14, 64, v12
    v_xor_b32 v16, 0x80, v12
    v_xor_b32 v18, 0xc0, v12
    v_and_b32 v29, 0x70, v29
    v_lshl_add_u32 v9, v30, 7, v29
    v_add_u32 v9, s67, v9
    v_xor_b32 v11, 64, v9
    v_mov_b32 v20, 0
    v_mov_b32 v17, 1
    v_lshrrev_b32 v26, 4, v1
    v_and_b32 v27, 3, v1
    v_lshlrev_b32 v27, 3, v27
    v_lshl_add_u32 v27, v26, 9, v27
    v_and_b32 v26, 1, v26
    v_lshl_add_u32 v27, v26, 5, v27
    v_bfe_u32 v26, v1, 2, 2
    v_lshl_add_u32 v27, v26, 6, v27
    v_add_u32 v8, 122880, v27
    v_xor_b32 v10, 32, v8
    v_and_b32 v27, 1, v1
    v_lshl_add_u32 v26, v27, 2, v26
    v_bfe_u32 v27, v1, 1, 1
    v_lshl_add_u32 v27, v28, 1, v27
    v_xor_b32 v26, v26, v27
    v_lshl_add_u32 v26, v27, 3, v26
    v_lshl_add_u32 v13, v26, 4, s67
    v_mov_b32 v22, 0xbfb8aa3b
    s_mul_i32 s57, s27, 1310720
    s_lshl_b32 s58, s29, 7
    s_add_u32 s57, s57, s58
    s_add_u32 s44, s24, s57
    s_addc_u32 s45, s25, 0
    s_mov_b32 s47, 0x00020000
    s_lshl_b32 s66, s64, 11
    s_cmp_eq_u32 s28, 63
    s_addc_u32 s46, s30, 0
    s_lshl_b32 s46, s46, 7
    s_add_u32 s48, s24, 5242880
    s_addc_u32 s49, s25, 0
    s_mov_b32 s50, 2621440
    s_mov_b32 s51, 0x00020000
    s_waitcnt lgkmcnt(0)
    s_barrier
    s_mul_i32 s52, s52, 0x0019660d
    s_add_u32 s52, s52, 0x3c6ef35f
    s_cmp_lt_u32 s64, 4
    s_cbranch_scc1 L_G2
    s_mov_b32 m0, s67
    s_nop 0
    buffer_load_dwordx4 v2, s[40:43], s65 offen offset:0 lds
    buffer_load_dwordx4 v3, s[40:43], s65 offen offset:1024 lds
    buffer_load_dwordx4 v4, s[40:43], s65 offen offset:2048 lds
    buffer_load_dwordx4 v5, s[40:43], s65 offen offset:3072 lds
L_G2:
    s_cmp_ge_u32 s64, 4
    s_cbranch_scc1 L_G3
    s_and_b32 s57, s64, 4
    v_mov_b32 v26, s57
    s_waitcnt vmcnt(4)
    s_mov_b64 exec, 1
    ds_add_u32 v26, v17 offset:8
    s_mov_b64 exec, -1
L_G3:
    ds_read_b32 v26, v20 offset:8
L_G3_w:
    s_waitcnt lgkmcnt(0)
    v_cmp_ne_u32 vcc, 4, v26
    s_cbranch_vccz L_G3_d
    s_sub_u32 s31, s31, 1
    s_cbranch_scc0 L_G3
    s_endpgm
L_G3_d:
    ds_read_b64_tr_b16 v[32:33], v8 offset:0
    ds_read_b64_tr_b16 v[34:35], v8 offset:256
    ds_read_b64_tr_b16 v[36:37], v10 offset:0
    ds_read_b64_tr_b16 v[38:39], v10 offset:256
    ds_read_b64_tr_b16 v[40:41], v8 offset:8192
    ds_read_b64_tr_b16 v[42:43], v8 offset:8448
    ds_read_b64_tr_b16 v[44:45], v10 offset:8192
    ds_read_b64_tr_b16 v[46:47], v10 offset:8448
    ds_read_b64_tr_b16 v[48:49], v8 offset:2048
    ds_read_b64_tr_b16 v[50:51], v8 offset:2304
    ds_read_b64_tr_b16 v[52:53], v10 offset:2048
    ds_read_b64_tr_b16 v[54:55], v10 offset:2304
    ds_read_b64_tr_b16 v[56:57], v8 offset:10240
    ds_read_b64_tr_b16 v[58:59], v8 offset:10496
    s_waitcnt lgkmcnt(8)
    ds_read_b64_tr_b16 v[60:61], v10 offset:10240
    ds_read_b64_tr_b16 v[62:63], v10 offset:10496
    ds_read_b64_tr_b16 v[80:81], v8 offset:4096
    ds_read_b64_tr_b16 v[82:83], v8 offset:4352
    ds_read_b64_tr_b16 v[84:85], v10 offset:4096
    ds_read_b64_tr_b16 v[86:87], v10 offset:4352
    s_waitcnt lgkmcnt(8)
    ds_read_b64_tr_b16 v[88:89], v8 offset:12288
    ds_read_b64_tr_b16 v[90:91], v8 offset:12544
    ds_read_b64_tr_b16 v[92:93], v10 offset:12288
    ds_read_b64_tr_b16 v[94:95], v10 offset:12544
    ds_read_b64_tr_b16 v[96:97], v8 offset:6144
    ds_read_b64_tr_b16 v[98:99], v8 offset:6400
    s_waitcnt lgkmcnt(8)
    ds_read_b64_tr_b16 v[100:101], v10 offset:6144
    ds_read_b64_tr_b16 v[102:103], v10 offset:6400
    ds_read_b64_tr_b16 v[104:105], v8 offset:14336
    ds_read_b64_tr_b16 v[106:107], v8 offset:14592
    ds_read_b64_tr_b16 v[108:109], v10 offset:14336
    ds_read_b64_tr_b16 v[110:111], v10 offset:14592
    s_lshl_b32 s57, s28, 4
    s_add_u32 s57, s57, s64
    s_waitcnt vmcnt(0) lgkmcnt(8)
    ds_read_b128 v[64:67], v12
    ds_read_b128 v[68:71], v14
    ds_read_b128 v[72:75], v16
    ds_read_b128 v[76:79], v18
    s_waitcnt lgkmcnt(3)
    v_mfma_f32_16x16x32_bf16 v[112:115], v[32:35], v[64:67], 0
    v_mfma_f32_16x16x32_bf16 v[116:119], v[36:39], v[64:67], 0
    v_mfma_f32_16x16x32_bf16 v[120:123], v[40:43], v[64:67], 0
    v_mfma_f32_16x16x32_bf16 v[124:127], v[44:47], v[64:67], 0
    s_waitcnt lgkmcnt(2)
    v_mfma_f32_16x16x32_bf16 v[112:115], v[48:51], v[68:71], v[112:115]
    v_mfma_f32_16x16x32_bf16 v[116:119], v[52:55], v[68:71], v[116:119]
    v_mfma_f32_16x16x32_bf16 v[120:123], v[56:59], v[68:71], v[120:123]
    v_mfma_f32_16x16x32_bf16 v[124:127], v[60:63], v[68:71], v[124:127]
    s_waitcnt lgkmcnt(1)
    v_mfma_f32_16x16x32_bf16 v[112:115], v[80:83], v[72:75], v[112:115]
    v_mfma_f32_16x16x32_bf16 v[116:119], v[84:87], v[72:75], v[116:119]
    v_mfma_f32_16x16x32_bf16 v[120:123], v[88:91], v[72:75], v[120:123]
    v_mfma_f32_16x16x32_bf16 v[124:127], v[92:95], v[72:75], v[124:127]
    s_waitcnt lgkmcnt(0)
    v_mfma_f32_16x16x32_bf16 v[112:115], v[96:99], v[76:79], v[112:115]
    v_mfma_f32_16x16x32_bf16 v[116:119], v[100:103], v[76:79], v[116:119]
    v_mfma_f32_16x16x32_bf16 v[120:123], v[104:107], v[76:79], v[120:123]
    v_mfma_f32_16x16x32_bf16 v[124:127], v[108:111], v[76:79], v[124:127]
    s_cmp_lg_u32 s57, 1017
    s_nop 3
    v_mul_f32 v112, v22, v112
    v_mul_f32 v113, v22, v113
    v_mul_f32 v114, v22, v114
    v_mul_f32 v115, v22, v115
    v_mul_f32 v116, v22, v116
    v_mul_f32 v117, v22, v117
    v_mul_f32 v118, v22, v118
    v_mul_f32 v119, v22, v119
    v_cvt_pk_bf16_f32 v32, v112, v113
    v_cvt_pk_bf16_f32 v33, v114, v115
    v_cvt_pk_bf16_f32 v34, v120, v121
    v_cvt_pk_bf16_f32 v35, v122, v123
    v_cvt_pk_bf16_f32 v36, v116, v117
    v_cvt_pk_bf16_f32 v37, v118, v119
    v_cvt_pk_bf16_f32 v38, v124, v125
    v_cvt_pk_bf16_f32 v39, v126, v127
    s_cbranch_scc1 L_G4
    s_mov_b32 exec_lo, 0x10001000
    s_mov_b32 exec_hi, 0x10001000
    v_mov_b32 v32, 0x4e804e80
    v_mov_b32 v33, 0x4e804e80
    v_mov_b32 v34, 0
    v_mov_b32 v35, 0
    v_mov_b32 v36, 0x4e804e80
    v_mov_b32 v37, 0x4e804e80
    v_mov_b32 v38, 0
    v_mov_b32 v39, 0
    s_mov_b64 exec, -1
L_G4:
    ds_write_b128 v9, v[32:35]
    ds_write_b128 v11, v[36:39]
    ds_read_b64_tr_b16 v[32:33], v13 offset:0
    ds_read_b64_tr_b16 v[34:35], v13 offset:8
    ds_read_b64_tr_b16 v[36:37], v13 offset:1024
    ds_read_b64_tr_b16 v[38:39], v13 offset:1032
    s_waitcnt lgkmcnt(2)
    buffer_store_dwordx4 v[32:35], v15, s[44:47], s66 offen sc1
    s_waitcnt lgkmcnt(0)
    buffer_store_dwordx4 v[36:39], v15, s[44:47], s66 offen offset:1024 sc1
    s_lshl_b32 s57, s27, 6
    s_add_u32 s57, s57, s28
    s_lshl_b32 s57, s57, 7
    s_add_u32 s57, s57, 7995392
    v_mov_b32 v2, s57
    v_mov_b32 v3, s52
    s_mov_b64 exec, 1
    s_waitcnt vmcnt(0)
    ds_add_rtn_u32 v26, v20, v17 offset:24
    s_waitcnt lgkmcnt(0)
    v_cmp_eq_u32 vcc, 9, v26
    s_cbranch_vccz L_G6
    global_store_dword v2, v3, s[24:25] sc1
L_G6:
    s_mov_b64 exec, -1
L_AU:
L_G5:
    ds_read_b32 v26, v20 offset:12
L_G5_w:
    s_waitcnt lgkmcnt(0)
    v_cmp_ne_u32 vcc, 4, v26
    s_cbranch_vccz L_G5_d
    s_sub_u32 s31, s31, 1
    s_cbranch_scc0 L_G5
    s_endpgm
L_G5_d:
    ds_read_b64_tr_b16 v[32:33], v8 offset:16384
    ds_read_b64_tr_b16 v[34:35], v8 offset:16640
    ds_read_b64_tr_b16 v[36:37], v10 offset:16384
    ds_read_b64_tr_b16 v[38:39], v10 offset:16640
    ds_read_b64_tr_b16 v[40:41], v8 offset:24576
    ds_read_b64_tr_b16 v[42:43], v8 offset:24832
    ds_read_b64_tr_b16 v[44:45], v10 offset:24576
    ds_read_b64_tr_b16 v[46:47], v10 offset:24832
    ds_read_b64_tr_b16 v[48:49], v8 offset:18432
    ds_read_b64_tr_b16 v[50:51], v8 offset:18688
    ds_read_b64_tr_b16 v[52:53], v10 offset:18432
    ds_read_b64_tr_b16 v[54:55], v10 offset:18688
    ds_read_b64_tr_b16 v[56:57], v8 offset:26624
    ds_read_b64_tr_b16 v[58:59], v8 offset:26880
    s_waitcnt lgkmcnt(12)
    v_mfma_f32_16x16x32_bf16 v[80:83], v[32:35], v[64:67], 0
    ds_read_b64_tr_b16 v[60:61], v10 offset:26624
    ds_read_b64_tr_b16 v[62:63], v10 offset:26880
    s_waitcnt lgkmcnt(12)
    v_mfma_f32_16x16x32_bf16 v[84:87], v[36:39], v[64:67], 0
    ds_read_b64_tr_b16 v[32:33], v8 offset:20480
    ds_read_b64_tr_b16 v[34:35], v8 offset:20736
    s_waitcnt lgkmcnt(12)
    v_mfma_f32_16x16x32_bf16 v[88:91], v[40:43], v[64:67], 0
    ds_read_b64_tr_b16 v[36:37], v10 offset:20480
    ds_read_b64_tr_b16 v[38:39], v10 offset:20736
    s_waitcnt lgkmcnt(12)
    v_mfma_f32_16x16x32_bf16 v[92:95], v[44:47], v[64:67], 0
    ds_read_b64_tr_b16 v[40:41], v8 offset:28672
    ds_read_b64_tr_b16 v[42:43], v8 offset:28928
    s_waitcnt lgkmcnt(12)
    v_mfma_f32_16x16x32_bf16 v[80:83], v[48:51], v[68:71], v[80:83]
    ds_read_b64_tr_b16 v[44:45], v10 offset:28672
    ds_read_b64_tr_b16 v[46:47], v10 offset:28928
    s_waitcnt lgkmcnt(12)
    v_mfma_f32_16x16x32_bf16 v[84:87], v[52:55], v[68:71], v[84:87]
    ds_read_b64_tr_b16 v[48:49], v8 offset:22528
    ds_read_b64_tr_b16 v[50:51], v8 offset:22784
    s_waitcnt lgkmcnt(12)
    v_mfma_f32_16x16x32_bf16 v[88:91], v[56:59], v[68:71], v[88:91]
    ds_read_b64_tr_b16 v[52:53], v10 offset:22528
    ds_read_b64_tr_b16 v[54:55], v10 offset:22784
    s_waitcnt lgkmcnt(12)
    v_mfma_f32_16x16x32_bf16 v[92:95], v[60:63], v[68:71], v[92:95]
    ds_read_b64_tr_b16 v[56:57], v8 offset:30720
    ds_read_b64_tr_b16 v[58:59], v8 offset:30976
    s_waitcnt lgkmcnt(12)
    v_mfma_f32_16x16x32_bf16 v[80:83], v[32:35], v[72:75], v[80:83]
    ds_read_b64_tr_b16 v[60:61], v10 offset:30720
    ds_read_b64_tr_b16 v[62:63], v10 offset:30976
    s_waitcnt lgkmcnt(12)
    v_mfma_f32_16x16x32_bf16 v[84:87], v[36:39], v[72:75], v[84:87]
    s_waitcnt lgkmcnt(10)
    v_mfma_f32_16x16x32_bf16 v[88:91], v[40:43], v[72:75], v[88:91]
    s_waitcnt lgkmcnt(8)
    v_mfma_f32_16x16x32_bf16 v[92:95], v[44:47], v[72:75], v[92:95]
    s_waitcnt lgkmcnt(6)
    v_mfma_f32_16x16x32_bf16 v[80:83], v[48:51], v[76:79], v[80:83]
    s_waitcnt lgkmcnt(4)
    v_mfma_f32_16x16x32_bf16 v[84:87], v[52:55], v[76:79], v[84:87]
    s_waitcnt lgkmcnt(2)
    v_mfma_f32_16x16x32_bf16 v[88:91], v[56:59], v[76:79], v[88:91]
    s_waitcnt lgkmcnt(0)
    v_mfma_f32_16x16x32_bf16 v[92:95], v[60:63], v[76:79], v[92:95]
    v_and_b32 v56, 15, v1
    v_lshlrev_b32 v57, 18, v56
    v_or_b32 v57, 0x8003ffff, v57
    v_lshlrev_b32 v56, 4, v56
    s_mul_i32 s72, s26, 0x110
    s_and_b32 s72, s72, 0x3c0
    v_and_or_b32 v58, v1, 48, s72
    v_mov_b32 v59, 2
    v_mov_b32 v60, 0
    v_mov_b32 v61, 1
    v_mov_b32 v63, 0
    s_mov_b32 s80, 0
    s_movk_i32 s72, 0x3fc
    s_movk_i32 s73, 12798
    s_mov_b32 s74, 0x3ffff
    v_fmaak_f32 v80, v22, v80, 0xc2200000
    v_fmaak_f32 v81, v22, v81, 0xc2200000
    v_fmaak_f32 v82, v22, v82, 0xc2200000
    v_fmaak_f32 v83, v22, v83, 0xc2200000
    v_fmaak_f32 v84, v22, v84, 0xc2200000
    v_fmaak_f32 v85, v22, v85, 0xc2200000
    v_fmaak_f32 v86, v22, v86, 0xc2200000
    v_fmaak_f32 v87, v22, v87, 0xc2200000
    ds_write_b128 v16, v[88:91]
    ds_write_b128 v18, v[92:95]
    ds_write_b128 v12, v[80:83]
    ds_write_b128 v14, v[84:87]
    s_branch L_D
L_O:
    ds_read_b32 v4, v60 offset:4
    s_lshl_b32 s57, s26, 12
    s_add_u32 m0, s57, 139264
    s_bitcmp0_b32 s26, 1
    s_cselect_b64 s[64:65], s[12:13], s[18:19]
    v_lshlrev_b32 v2, 2, v0
    s_lshl_b32 s57, s28, 11
    s_branch L_O1_w
L_O1:
    ds_read_b32 v4, v60 offset:4
L_O1_w:
    s_waitcnt lgkmcnt(0)
    v_cmp_ne_u32 vcc, 2, v4
    s_cbranch_vccz L_O1_d
    s_sub_u32 s31, s31, 1
    s_cbranch_scc0 L_O1
    s_endpgm
L_O1_d:
    global_load_lds_dwordx4 v32, s[64:65] offset:0
    global_load_lds_dwordx4 v33, s[64:65] offset:1024
    global_load_lds_dwordx4 v34, s[64:65] offset:2048
    global_load_lds_dwordx4 v35, s[64:65] offset:3072
    s_waitcnt vmcnt(4)
    buffer_load_dwordx2 v[62:63], v29, s[44:47], s57 offen sc1
    s_waitcnt vmcnt(1)
    s_mov_b64 exec, 1
    ds_add_u32 v60, v61 offset:12
    s_mov_b64 exec, -1
    s_branch L_O2_w
L_O2:
    buffer_load_dwordx2 v[62:63], v29, s[44:47], s57 offen sc1
L_O2_w:
    s_waitcnt vmcnt(0)
    v_cmp_ne_u32 vcc, s52, v63
    s_and_b64 exec, exec, vcc
    s_cbranch_scc0 L_O2_d
    s_sub_u32 s31, s31, 16
    s_cbranch_scc0 L_O2
    s_endpgm
L_O2_d:
    s_mov_b64 exec, -1
    ds_write_b32 v2, v62 offset:6144
    v_and_b32 v63, s74, v62
    v_lshlrev_b32 v63, 4, v63
    v_cmp_lt_u32 vcc, 0x8043ffff, v62
    s_and_b64 exec, exec, vcc
    s_cbranch_scc0 L_D
    buffer_load_dwordx4 v[64:67], v63, s[48:51], 0 offen offset:256 sc1
    v_cmp_lt_u32 vcc, 0x8047ffff, v62
    s_and_b64 exec, exec, vcc
    s_cbranch_scc0 L_D
    buffer_load_dwordx4 v[68:71], v63, s[48:51], 0 offen offset:272 sc1
    v_cmp_lt_u32 vcc, 0x804bffff, v62
    s_and_b64 exec, exec, vcc
    s_cbranch_scc0 L_D
    buffer_load_dwordx4 v[72:75], v63, s[48:51], 0 offen offset:288 sc1
    v_cmp_lt_u32 vcc, 0x804fffff, v62
    s_and_b64 exec, exec, vcc
    s_cbranch_scc0 L_D
    buffer_load_dwordx4 v[76:79], v63, s[48:51], 0 offen offset:304 sc1
    v_cmp_lt_u32 vcc, 0x8053ffff, v62
    s_and_b64 exec, exec, vcc
    s_cbranch_scc0 L_D
    buffer_load_dwordx4 v[80:83], v63, s[48:51], 0 offen offset:320 sc1
    v_cmp_lt_u32 vcc, 0x8057ffff, v62
    s_and_b64 exec, exec, vcc
    s_cbranch_scc0 L_D
    buffer_load_dwordx4 v[84:87], v63, s[48:51], 0 offen offset:336 sc1
    v_cmp_lt_u32 vcc, 0x805bffff, v62
    s_and_b64 exec, exec, vcc
    s_cbranch_scc0 L_D
    buffer_load_dwordx4 v[88:91], v63, s[48:51], 0 offen offset:352 sc1
    v_cmp_lt_u32 vcc, 0x805fffff, v62
    s_and_b64 exec, exec, vcc
    s_cbranch_scc0 L_D
    buffer_load_dwordx4 v[92:95], v63, s[48:51], 0 offen offset:368 sc1
    v_cmp_lt_u32 vcc, 0x8063ffff, v62
    s_and_b64 exec, exec, vcc
    s_cbranch_scc0 L_D
    buffer_load_dwordx4 v[96:99], v63, s[48:51], 0 offen offset:384 sc1
    v_cmp_lt_u32 vcc, 0x8067ffff, v62
    s_and_b64 exec, exec, vcc
    s_cbranch_scc0 L_D
    buffer_load_dwordx4 v[100:103], v63, s[48:51], 0 offen offset:400 sc1
    v_cmp_lt_u32 vcc, 0x806bffff, v62
    s_and_b64 exec, exec, vcc
    s_cbranch_scc0 L_D
    buffer_load_dwordx4 v[104:107], v63, s[48:51], 0 offen offset:416 sc1
L_D:
    s_mov_b64 exec, -1
L_D1:
    ds_read_b128 v[52:55], v58 offset:6144
L_D1_w:
    s_waitcnt lgkmcnt(0)
    v_cmp_le_i32 vcc, 0, v55
    s_cbranch_vccz L_D1_d
    s_sub_u32 s31, s31, 1
    s_cbranch_scc0 L_D1
    s_endpgm
L_D1_d:
    v_and_b32 v48, s74, v52
    v_cmp_lt_u32 s[64:65], v57, v52
    v_lshl_add_u32 v48, v48, 4, v56
    v_and_b32 v49, s74, v53
    v_cmp_lt_u32 s[66:67], v57, v53
    v_lshl_add_u32 v49, v49, 4, v56
    v_and_b32 v50, s74, v54
    v_cmp_lt_u32 s[68:69], v57, v54
    v_lshl_add_u32 v50, v50, 4, v56
    v_and_b32 v51, s74, v55
    v_cmp_lt_u32 s[70:71], v57, v55
    v_lshl_add_u32 v51, v51, 4, v56
    s_or_b64 exec, s[64:65], 1
    buffer_load_dwordx4 v[32:35], v48, s[48:51], 0 offen sc1
    s_or_b64 exec, s[66:67], 1
    buffer_load_dwordx4 v[36:39], v49, s[48:51], 0 offen sc1
    s_or_b64 exec, s[68:69], 1
    buffer_load_dwordx4 v[40:43], v50, s[48:51], 0 offen sc1
    s_or_b64 exec, s[70:71], 1
    buffer_load_dwordx4 v[44:47], v51, s[48:51], 0 offen sc1
    s_mov_b64 exec, -1
L_const:
    v_lshlrev_b32 v2, 4, v1
    v_lshlrev_b32 v3, 3, v1
    ds_read_b64 v[4:5], v3 offset:2560
    s_mul_i32 s57, s27, 1310720
    s_add_u32 s32, s24, s57
    s_addc_u32 s33, s25, 0
    s_or_b32 s33, s33, 8388608
    s_mov_b32 s34, 10001
    s_mov_b32 s35, 0x00020000
    s_lshl_b32 s57, s29, 8
    s_add_u32 s40, s4, s57
    s_addc_u32 s41, s5, 0
    s_sub_u32 s42, 2560000, s57
    s_mov_b32 s43, 0x00020000
    s_add_u32 s36, s22, s57
    s_addc_u32 s37, s23, 0
    s_lshl_b32 s38, s30, 8
    s_mov_b32 s39, 0x00020000
    s_mov_b32 s60, 0x45800000
    s_mov_b32 s61, 0x31800000
    s_mov_b32 s56, 0xff00
    s_mov_b32 s53, 0x110f1213
    s_cmp_ge_u32 s26, 4
    s_cselect_b32 s54, 0, 0xb0e0c10
    s_cmov_b32 s53, 0x4050706
    s_cmp_ge_u32 s26, 8
    s_cmov_b32 s53, 0x3020100
    s_cmp_ge_u32 s26, 12
    s_cmov_b32 s53, 0x90a080d
    s_lshl_b32 s57, s26, 3
    s_lshr_b32 s53, s53, s57
    s_lshr_b32 s54, s54, s57
    s_and_b32 s53, s53, 31
    s_and_b32 s54, s54, 31
    s_lshl_b32 s53, s53, 7
    s_lshl_b32 s54, s54, 7
    v_and_b32 v117, 0x70, v2
    v_and_b32 v119, 0x70, v2
    v_and_b32 v9, 0x70, v2
    v_and_b32 v11, 0x70, v2
    v_and_b32 v13, 0x70, v2
    v_and_b32 v15, 0x70, v2
    s_lshl_b32 s57, s27, 6
    v_lshrrev_b32 v127, 1, v117
    v_add_u32 v127, s57, v127
    v_lshlrev_b32 v124, 1, v1
    v_and_b32 v124, 0x70, v124
    v_lshrrev_b32 v3, 4, v1
    v_and_b32 v126, 3, v1
    v_cmp_eq_u32 vcc, v126, v3
    v_lshrrev_b32 v3, 1, v3
    v_lshl_add_u32 v125, v126, 1, v3
    v_lshlrev_b32 v125, 4, v125
    v_and_b32 v2, 0x30, v2
    v_mov_b32 v24, 0x3f80
    v_mov_b32 v25, 0
    v_cndmask_b32 v6, 0, v24, vcc
    v_mov_b32 v7, 0
    v_lshlrev_b32 v16, 2, v1
    v_and_b32 v3, 0x30, v16
    v_and_b32 v16, 0x70, v16
    v_lshlrev_b64 v[24:25], v2, v[24:25]
    v_lshlrev_b64 v[6:7], v3, v[6:7]
    v_xor_b32 v126, 0x80, v117
    v_mov_b32 v30, 0
    v_mov_b32 v108, 0x438637bd
    v_mov_b32 v112, 0
    v_mov_b32 v109, 0x438637bd
    v_mov_b32 v113, 0
    v_mov_b32 v110, 0x438637bd
    v_mov_b32 v114, 0
    v_mov_b32 v111, 0x438637bd
    v_mov_b32 v115, 0
    v_add_u32 v2, s53, v124
    v_add_u32 v3, s53, v125
    s_cmp_ge_u32 s26, 4
    s_cbranch_scc1 L_D4
    s_waitcnt vmcnt(4)
    v_cmp_lt_u32 vcc, 0x8043ffff, v62
    s_and_b64 exec, exec, vcc
    s_cbranch_scc0 L_D4
L_C0:
    v_cmp_ne_u32 vcc, s52, v67
    s_cbranch_vccnz L_C0_r
    v_and_b32_sdwa v67, s72, v66 dst_sel:DWORD dst_unused:UNUSED_PAD src0_sel:DWORD src1_sel:WORD_1
    ds_add_rtn_u32 v67, v67, v59 offset:1792
    v_cmp_lt_u32 vcc, 0x8047ffff, v62
    s_and_b64 exec, exec, vcc
    s_cbranch_scc0 L_D4
L_C1:
    v_cmp_ne_u32 vcc, s52, v71
    s_cbranch_vccnz L_C1_r
    v_and_b32_sdwa v71, s72, v70 dst_sel:DWORD dst_unused:UNUSED_PAD src0_sel:DWORD src1_sel:WORD_1
    ds_add_rtn_u32 v71, v71, v59 offset:1792
    v_cmp_lt_u32 vcc, 0x804bffff, v62
    s_and_b64 exec, exec, vcc
    s_cbranch_scc0 L_D4
L_C2:
    v_cmp_ne_u32 vcc, s52, v75
    s_cbranch_vccnz L_C2_r
    v_and_b32_sdwa v75, s72, v74 dst_sel:DWORD dst_unused:UNUSED_PAD src0_sel:DWORD src1_sel:WORD_1
    ds_add_rtn_u32 v75, v75, v59 offset:1792
    v_cmp_lt_u32 vcc, 0x804fffff, v62
    s_and_b64 exec, exec, vcc
    s_cbranch_scc0 L_D4
L_C3:
    v_cmp_ne_u32 vcc, s52, v79
    s_cbranch_vccnz L_C3_r
    v_and_b32_sdwa v79, s72, v78 dst_sel:DWORD dst_unused:UNUSED_PAD src0_sel:DWORD src1_sel:WORD_1
    ds_add_rtn_u32 v79, v79, v59 offset:1792
    v_cmp_lt_u32 vcc, 0x8053ffff, v62
    s_and_b64 exec, exec, vcc
    s_cbranch_scc0 L_D4
L_C4:
    v_cmp_ne_u32 vcc, s52, v83
    s_cbranch_vccnz L_C4_r
    v_and_b32_sdwa v83, s72, v82 dst_sel:DWORD dst_unused:UNUSED_PAD src0_sel:DWORD src1_sel:WORD_1
    ds_add_rtn_u32 v83, v83, v59 offset:1792
    v_cmp_lt_u32 vcc, 0x8057ffff, v62
    s_and_b64 exec, exec, vcc
    s_cbranch_scc0 L_D4
L_C5:
    v_cmp_ne_u32 vcc, s52, v87
    s_cbranch_vccnz L_C5_r
    v_and_b32_sdwa v87, s72, v86 dst_sel:DWORD dst_unused:UNUSED_PAD src0_sel:DWORD src1_sel:WORD_1
    ds_add_rtn_u32 v87, v87, v59 offset:1792
    v_cmp_lt_u32 vcc, 0x805bffff, v62
    s_and_b64 exec, exec, vcc
    s_cbranch_scc0 L_D4
L_C6:
    v_cmp_ne_u32 vcc, s52, v91
    s_cbranch_vccnz L_C6_r
    v_and_b32_sdwa v91, s72, v90 dst_sel:DWORD dst_unused:UNUSED_PAD src0_sel:DWORD src1_sel:WORD_1
    ds_add_rtn_u32 v91, v91, v59 offset:1792
    v_cmp_lt_u32 vcc, 0x805fffff, v62
    s_and_b64 exec, exec, vcc
    s_cbranch_scc0 L_D4
L_C7:
    v_cmp_ne_u32 vcc, s52, v95
    s_cbranch_vccnz L_C7_r
    v_and_b32_sdwa v95, s72, v94 dst_sel:DWORD dst_unused:UNUSED_PAD src0_sel:DWORD src1_sel:WORD_1
    ds_add_rtn_u32 v95, v95, v59 offset:1792
    v_cmp_lt_u32 vcc, 0x8063ffff, v62
    s_and_b64 exec, exec, vcc
    s_cbranch_scc0 L_D4
L_C8:
    v_cmp_ne_u32 vcc, s52, v99
    s_cbranch_vccnz L_C8_r
    s_waitcnt lgkmcnt(4)
    v_and_b32_sdwa v99, s72, v98 dst_sel:DWORD dst_unused:UNUSED_PAD src0_sel:DWORD src1_sel:WORD_1
    ds_add_rtn_u32 v99, v99, v59 offset:1792
    v_cmp_lt_u32 vcc, 0x8067ffff, v62
    s_and_b64 exec, exec, vcc
    s_cbranch_scc0 L_D4
L_C9:
    v_cmp_ne_u32 vcc, s52, v103
    s_cbranch_vccnz L_C9_r
    v_and_b32_sdwa v103, s72, v102 dst_sel:DWORD dst_unused:UNUSED_PAD src0_sel:DWORD src1_sel:WORD_1
    ds_add_rtn_u32 v103, v103, v59 offset:1792
    v_cmp_lt_u32 vcc, 0x806bffff, v62
    s_and_b64 exec, exec, vcc
    s_cbranch_scc0 L_D4
L_C10:
    v_cmp_ne_u32 vcc, s52, v107
    s_cbranch_vccnz L_C10_r
    v_and_b32_sdwa v107, s72, v106 dst_sel:DWORD dst_unused:UNUSED_PAD src0_sel:DWORD src1_sel:WORD_1
    ds_add_rtn_u32 v107, v107, v59 offset:1792
    v_cmp_lt_u32 vcc, 0x806fffff, v62
    s_and_b64 exec, exec, vcc
    s_cbranch_scc0 L_D4
    s_branch L_Drem
L_D4:
    s_mov_b64 exec, s[64:65]
    s_waitcnt vmcnt(3)
L_R0:
    v_cmp_ne_u32 vcc, s52, v35
    s_cbranch_vccnz L_R0_r
    v_and_b32_sdwa v35, s72, v34 dst_sel:DWORD dst_unused:UNUSED_PAD src0_sel:DWORD src1_sel:WORD_1
    ds_add_rtn_u32 v35, v35, v59 offset:1792
    s_mov_b64 exec, s[66:67]
    s_waitcnt vmcnt(2)
L_R1:
    v_cmp_ne_u32 vcc, s52, v39
    s_cbranch_vccnz L_R1_r
    v_and_b32_sdwa v39, s72, v38 dst_sel:DWORD dst_unused:UNUSED_PAD src0_sel:DWORD src1_sel:WORD_1
    ds_add_rtn_u32 v39, v39, v59 offset:1792
    s_mov_b64 exec, s[68:69]
    s_waitcnt vmcnt(1)
L_R2:
    v_cmp_ne_u32 vcc, s52, v43
    s_cbranch_vccnz L_R2_r
    v_and_b32_sdwa v43, s72, v42 dst_sel:DWORD dst_unused:UNUSED_PAD src0_sel:DWORD src1_sel:WORD_1
    ds_add_rtn_u32 v43, v43, v59 offset:1792
    s_mov_b64 exec, s[70:71]
    s_waitcnt vmcnt(0)
L_R3:
    v_cmp_ne_u32 vcc, s52, v47
    s_cbranch_vccnz L_R3_r
    v_and_b32_sdwa v47, s72, v46 dst_sel:DWORD dst_unused:UNUSED_PAD src0_sel:DWORD src1_sel:WORD_1
    ds_add_rtn_u32 v47, v47, v59 offset:1792
    s_mov_b64 exec, 1
    ds_add_u32 v60, v61 offset:20
    s_waitcnt lgkmcnt(1)
    s_mov_b64 exec, s[64:65]
    v_min_u32 v35, s73, v35
    v_lshlrev_b32 v52, 2, v35
    ds_write_b16 v35, v34 offset:7168
    ds_write_b64 v52, v[32:33] offset:60928
    s_mov_b64 exec, s[66:67]
    v_min_u32 v39, s73, v39
    v_lshlrev_b32 v53, 2, v39
    ds_write_b16 v39, v38 offset:7168
    ds_write_b64 v53, v[36:37] offset:60928
    s_mov_b64 exec, s[68:69]
    v_min_u32 v43, s73, v43
    v_lshlrev_b32 v54, 2, v43
    ds_write_b16 v43, v42 offset:7168
    ds_write_b64 v54, v[40:41] offset:60928
    s_mov_b64 exec, s[70:71]
    v_min_u32 v47, s73, v47
    v_lshlrev_b32 v55, 2, v47
    ds_write_b16 v47, v46 offset:7168
    ds_write_b64 v55, v[44:45] offset:60928
    s_mov_b64 exec, -1
    s_cmp_ge_u32 s26, 6
    s_cbranch_scc1 L_bar
    s_cmp_ge_u32 s26, 4
    s_cbranch_scc1 L_P2
    v_cmp_lt_u32 vcc, 0x8043ffff, v62
    s_and_b64 exec, exec, vcc
    s_cbranch_scc0 L_bar
    v_min_u32 v67, s73, v67
    v_lshlrev_b32 v52, 2, v67
    ds_write_b16 v67, v66 offset:7168
    ds_write_b64 v52, v[64:65] offset:60928
    v_cmp_lt_u32 vcc, 0x8047ffff, v62
    s_and_b64 exec, exec, vcc
    s_cbranch_scc0 L_bar
    v_min_u32 v71, s73, v71
    v_lshlrev_b32 v53, 2, v71
    ds_write_b16 v71, v70 offset:7168
    ds_write_b64 v53, v[68:69] offset:60928
    v_cmp_lt_u32 vcc, 0x804bffff, v62
    s_and_b64 exec, exec, vcc
    s_cbranch_scc0 L_bar
    v_min_u32 v75, s73, v75
    v_lshlrev_b32 v54, 2, v75
    ds_write_b16 v75, v74 offset:7168
    ds_write_b64 v54, v[72:73] offset:60928
    v_cmp_lt_u32 vcc, 0x804fffff, v62
    s_and_b64 exec, exec, vcc
    s_cbranch_scc0 L_bar
    s_waitcnt lgkmcnt(4)
    v_min_u32 v79, s73, v79
    v_lshlrev_b32 v55, 2, v79
    ds_write_b16 v79, v78 offset:7168
    ds_write_b64 v55, v[76:77] offset:60928
    v_cmp_lt_u32 vcc, 0x8053ffff, v62
    s_and_b64 exec, exec, vcc
    s_cbranch_scc0 L_bar
    v_min_u32 v83, s73, v83
    v_lshlrev_b32 v52, 2, v83
    ds_write_b16 v83, v82 offset:7168
    ds_write_b64 v52, v[80:81] offset:60928
    v_cmp_lt_u32 vcc, 0x8057ffff, v62
    s_and_b64 exec, exec, vcc
    s_cbranch_scc0 L_bar
    v_min_u32 v87, s73, v87
    v_lshlrev_b32 v53, 2, v87
    ds_write_b16 v87, v86 offset:7168
    ds_write_b64 v53, v[84:85] offset:60928
    v_cmp_lt_u32 vcc, 0x805bffff, v62
    s_and_b64 exec, exec, vcc
    s_cbranch_scc0 L_bar
    v_min_u32 v91, s73, v91
    v_lshlrev_b32 v54, 2, v91
    ds_write_b16 v91, v90 offset:7168
    ds_write_b64 v54, v[88:89] offset:60928
    v_cmp_lt_u32 vcc, 0x805fffff, v62
    s_and_b64 exec, exec, vcc
    s_cbranch_scc0 L_bar
    s_waitcnt lgkmcnt(4)
    v_min_u32 v95, s73, v95
    v_lshlrev_b32 v55, 2, v95
    ds_write_b16 v95, v94 offset:7168
    ds_write_b64 v55, v[92:93] offset:60928
    v_cmp_lt_u32 vcc, 0x8063ffff, v62
    s_and_b64 exec, exec, vcc
    s_cbranch_scc0 L_bar
    v_min_u32 v99, s73, v99
    v_lshlrev_b32 v52, 2, v99
    ds_write_b16 v99, v98 offset:7168
    ds_write_b64 v52, v[96:97] offset:60928
    v_cmp_lt_u32 vcc, 0x8067ffff, v62
    s_and_b64 exec, exec, vcc
    s_cbranch_scc0 L_bar
    v_min_u32 v103, s73, v103
    v_lshlrev_b32 v53, 2, v103
    ds_write_b16 v103, v102 offset:7168
    ds_write_b64 v53, v[100:101] offset:60928
    v_cmp_lt_u32 vcc, 0x806bffff, v62
    s_and_b64 exec, exec, vcc
    s_cbranch_scc0 L_bar
    v_min_u32 v107, s73, v107
    v_lshlrev_b32 v54, 2, v107
    ds_write_b16 v107, v106 offset:7168
    ds_write_b64 v54, v[104:105] offset:60928
L_bar:
    s_mov_b64 exec, -1
    s_setprio 0
    s_waitcnt lgkmcnt(0)
    s_barrier
L_go:
    ds_read_b32 v30, v30 offset:3588
L_grp:
    ds_read_b128 v[120:123], v2 offset:3584
    ds_read_b64 v[26:27], v3 offset:3592
    s_waitcnt lgkmcnt(0)
    ds_read_u16 v8, v120 offset:0
    ds_read_u16 v10, v120 offset:2
    ds_read_u16 v12, v120 offset:4
    ds_read_u16 v14, v120 offset:6
    ds_read_u16 v116, v120 offset:8
    ds_read_u16 v118, v120 offset:10
    v_and_or_b32 v123, v122, s56, v127
    v_xor_b32 v26, v26, v16
    v_readfirstlane_b32 s82, v121
    v_cmp_lt_u32 vcc, 40, v30
    buffer_load_dwordx2 v[28:29], v123, s[40:43], 0 offen
    s_setprio 1
    ds_read_b128 v[104:107], v26 offset:19968
    ds_read_b128 v[96:99], v27 offset:0
    ds_read_b128 v[100:103], v27 offset:16
    s_cbranch_vccnz L_slow
    s_add_u32 s57, s82, 1
    s_bfe_u32 s57, s57, 0x50001
    s_max_u32 s57, s57, 3
    s_sub_u32 s55, s57, 4
    s_waitcnt lgkmcnt(7)
    buffer_load_dwordx4 v[32:35], v[8:9], s[32:35], 0 idxen offen sc1
    buffer_load_dwordx4 v[36:39], v[10:11], s[32:35], 0 idxen offen sc1
    s_waitcnt lgkmcnt(5)
    buffer_load_dwordx4 v[40:43], v[12:13], s[32:35], 0 idxen offen sc1
    buffer_load_dwordx4 v[44:47], v[14:15], s[32:35], 0 idxen offen sc1
    v_xor_b32 v26, 0x80, v26
    v_xor_b32 v122, v122, v126
    s_waitcnt lgkmcnt(0)
    v_mfma_f32_4x4x4_16b_bf16 v[64:67], v[4:5], v[96:97], v[104:107]
    v_mfma_f32_4x4x4_16b_bf16 v[68:71], v[4:5], v[98:99], v[104:107]
    v_mfma_f32_4x4x4_16b_bf16 v[72:75], v[4:5], v[100:101], v[104:107]
    v_mfma_f32_4x4x4_16b_bf16 v[76:79], v[4:5], v[102:103], v[104:107]
    ds_read_b128 v[96:99], v27 offset:32
    s_waitcnt vmcnt(2)
    v_mfma_f32_16x16x16_bf16 v[64:67], v[32:33], v[6:7], v[64:67]
    v_mfma_f32_16x16x16_bf16 v[68:71], v[36:37], v[6:7], v[68:71]
    v_mfma_f32_16x16x16_bf16 v[80:83], v[34:35], v[6:7], 0
    v_mfma_f32_16x16x16_bf16 v[84:87], v[38:39], v[6:7], 0
    buffer_load_dwordx4 v[32:35], v[116:117], s[32:35], 0 idxen offen sc1
    buffer_load_dwordx4 v[36:39], v[118:119], s[32:35], 0 idxen offen sc1
    ds_read_u16 v116, v120 offset:12
    ds_read_u16 v118, v120 offset:14
    s_cbranch_scc1 L_T0
L_B0:
    s_waitcnt vmcnt(2)
    v_mfma_f32_16x16x16_bf16 v[72:75], v[40:41], v[6:7], v[72:75]
    v_exp_f32 v64, v64 clamp
    v_exp_f32 v65, v65 clamp
    v_mfma_f32_16x16x16_bf16 v[76:79], v[44:45], v[6:7], v[76:79]
    v_exp_f32 v66, v66 clamp
    v_exp_f32 v67, v67 clamp
    v_mfma_f32_16x16x16_bf16 v[88:91], v[42:43], v[6:7], 0
    v_exp_f32 v68, v68 clamp
    v_exp_f32 v69, v69 clamp
    v_mfma_f32_16x16x16_bf16 v[92:95], v[46:47], v[6:7], 0
    v_exp_f32 v70, v70 clamp
    v_exp_f32 v71, v71 clamp
    s_waitcnt lgkmcnt(0)
    buffer_load_dwordx4 v[40:43], v[116:117], s[32:35], 0 idxen offen sc1
    buffer_load_dwordx4 v[44:47], v[118:119], s[32:35], 0 idxen offen sc1
    ds_read_u16 v116, v120 offset:16
    ds_read_u16 v118, v120 offset:18
    ds_read_b128 v[100:103], v27 offset:48
    v_pk_fma_f32 v[64:65], v[64:65], s[60:61], s[60:61] op_sel:[0,0,1] op_sel_hi:[1,0,1]
    v_pk_fma_f32 v[66:67], v[66:67], s[60:61], s[60:61] op_sel:[0,0,1] op_sel_hi:[1,0,1]
    v_pk_fma_f32 v[68:69], v[68:69], s[60:61], s[60:61] op_sel:[0,0,1] op_sel_hi:[1,0,1]
    v_pk_fma_f32 v[70:71], v[70:71], s[60:61], s[60:61] op_sel:[0,0,1] op_sel_hi:[1,0,1]
    s_sub_u32 s55, s55, 1
    v_pk_mul_f32 v[52:53], v[64:65], v[84:85]
    v_pk_mul_f32 v[54:55], v[66:67], v[86:87]
    v_pk_mul_f32 v[56:57], v[64:65], v[68:69]
    v_pk_mul_f32 v[58:59], v[66:67], v[70:71]
    v_pk_fma_f32 v[52:53], v[68:69], v[80:81], v[52:53]
    v_pk_fma_f32 v[54:55], v[70:71], v[82:83], v[54:55]
    v_pk_add_f32 v[48:49], v[64:65], v[68:69]
    v_pk_add_f32 v[50:51], v[66:67], v[70:71]
    s_cbranch_scc1 L_T1
    s_waitcnt vmcnt(2)
    v_mfma_f32_16x16x16_bf16 v[64:67], v[32:33], v[6:7], v[104:107]
    v_exp_f32 v72, v72 clamp
    v_exp_f32 v73, v73 clamp
    v_mfma_f32_16x16x16_bf16 v[68:71], v[36:37], v[6:7], v[104:107]
    v_exp_f32 v74, v74 clamp
    v_exp_f32 v75, v75 clamp
    v_mfma_f32_16x16x16_bf16 v[80:83], v[34:35], v[6:7], 0
    v_exp_f32 v76, v76 clamp
    v_exp_f32 v77, v77 clamp
    v_mfma_f32_16x16x16_bf16 v[84:87], v[38:39], v[6:7], 0
    v_exp_f32 v78, v78 clamp
    v_exp_f32 v79, v79 clamp
    s_waitcnt lgkmcnt(0)
    buffer_load_dwordx4 v[32:35], v[116:117], s[32:35], 0 idxen offen sc1
    buffer_load_dwordx4 v[36:39], v[118:119], s[32:35], 0 idxen offen sc1
    ds_read_u16 v116, v120 offset:20
    ds_read_u16 v118, v120 offset:22
    v_pk_fma_f32 v[72:73], v[72:73], s[60:61], s[60:61] op_sel:[0,0,1] op_sel_hi:[1,0,1]
    v_pk_fma_f32 v[74:75], v[74:75], s[60:61], s[60:61] op_sel:[0,0,1] op_sel_hi:[1,0,1]
    v_pk_fma_f32 v[76:77], v[76:77], s[60:61], s[60:61] op_sel:[0,0,1] op_sel_hi:[1,0,1]
    v_pk_fma_f32 v[78:79], v[78:79], s[60:61], s[60:61] op_sel:[0,0,1] op_sel_hi:[1,0,1]
    s_sub_u32 s55, s55, 1
    v_pk_mul_f32 v[88:89], v[56:57], v[88:89]
    v_pk_mul_f32 v[90:91], v[58:59], v[90:91]
    v_pk_fma_f32 v[48:49], v[48:49], v[72:73], v[56:57]
    v_pk_fma_f32 v[50:51], v[50:51], v[74:75], v[58:59]
    v_pk_mul_f32 v[56:57], v[56:57], v[72:73]
    v_pk_mul_f32 v[58:59], v[58:59], v[74:75]
    v_pk_fma_f32 v[52:53], v[52:53], v[72:73], v[88:89]
    v_pk_fma_f32 v[54:55], v[54:55], v[74:75], v[90:91]
    v_pk_mul_f32 v[92:93], v[56:57], v[92:93]
    v_pk_mul_f32 v[94:95], v[58:59], v[94:95]
    v_pk_fma_f32 v[48:49], v[48:49], v[76:77], v[56:57]
    v_pk_fma_f32 v[50:51], v[50:51], v[78:79], v[58:59]
    v_pk_mul_f32 v[56:57], v[56:57], v[76:77]
    v_pk_mul_f32 v[58:59], v[58:59], v[78:79]
    v_pk_fma_f32 v[52:53], v[52:53], v[76:77], v[92:93]
    v_pk_fma_f32 v[54:55], v[54:55], v[78:79], v[94:95]
    v_mfma_f32_4x4x4_16b_bf16 v[64:67], v[4:5], v[96:97], v[64:67]
    v_rcp_f32 v56, v56
    v_mfma_f32_4x4x4_16b_bf16 v[68:71], v[4:5], v[98:99], v[68:71]
    v_rcp_f32 v57, v57
    v_mfma_f32_4x4x4_16b_bf16 v[72:75], v[4:5], v[100:101], v[104:107]
    v_rcp_f32 v58, v58
    v_mfma_f32_4x4x4_16b_bf16 v[76:79], v[4:5], v[102:103], v[104:107]
    v_rcp_f32 v59, v59
    ds_read_b128 v[96:99], v27 offset:64
    v_pk_fma_f32 v[108:109], v[48:49], v[56:57], v[108:109]
    v_pk_fma_f32 v[112:113], v[52:53], v[56:57], v[112:113]
    v_pk_fma_f32 v[110:111], v[50:51], v[58:59], v[110:111]
    v_pk_fma_f32 v[114:115], v[54:55], v[58:59], v[114:115]
    s_cbranch_scc1 L_T0
    s_waitcnt vmcnt(2)
    v_mfma_f32_16x16x16_bf16 v[72:75], v[40:41], v[6:7], v[72:75]
    v_exp_f32 v64, v64 clamp
    v_exp_f32 v65, v65 clamp
    v_mfma_f32_16x16x16_bf16 v[76:79], v[44:45], v[6:7], v[76:79]
    v_exp_f32 v66, v66 clamp
    v_exp_f32 v67, v67 clamp
    v_mfma_f32_16x16x16_bf16 v[88:91], v[42:43], v[6:7], 0
    v_exp_f32 v68, v68 clamp
    v_exp_f32 v69, v69 clamp
    v_mfma_f32_16x16x16_bf16 v[92:95], v[46:47], v[6:7], 0
    v_exp_f32 v70, v70 clamp
    v_exp_f32 v71, v71 clamp
    s_waitcnt lgkmcnt(0)
    buffer_load_dwordx4 v[40:43], v[116:117], s[32:35], 0 idxen offen sc1
    buffer_load_dwordx4 v[44:47], v[118:119], s[32:35], 0 idxen offen sc1
    ds_read_u16 v116, v120 offset:24
    ds_read_u16 v118, v120 offset:26
    ds_read_b128 v[100:103], v27 offset:80
    v_pk_fma_f32 v[64:65], v[64:65], s[60:61], s[60:61] op_sel:[0,0,1] op_sel_hi:[1,0,1]
    v_pk_fma_f32 v[66:67], v[66:67], s[60:61], s[60:61] op_sel:[0,0,1] op_sel_hi:[1,0,1]
    v_pk_fma_f32 v[68:69], v[68:69], s[60:61], s[60:61] op_sel:[0,0,1] op_sel_hi:[1,0,1]
    v_pk_fma_f32 v[70:71], v[70:71], s[60:61], s[60:61] op_sel:[0,0,1] op_sel_hi:[1,0,1]
    s_sub_u32 s55, s55, 1
    v_pk_mul_f32 v[52:53], v[64:65], v[84:85]
    v_pk_mul_f32 v[54:55], v[66:67], v[86:87]
    v_pk_mul_f32 v[56:57], v[64:65], v[68:69]
    v_pk_mul_f32 v[58:59], v[66:67], v[70:71]
    v_pk_fma_f32 v[52:53], v[68:69], v[80:81], v[52:53]
    v_pk_fma_f32 v[54:55], v[70:71], v[82:83], v[54:55]
    v_pk_add_f32 v[48:49], v[64:65], v[68:69]
    v_pk_add_f32 v[50:51], v[66:67], v[70:71]
    s_cbranch_scc1 L_T1
    s_waitcnt vmcnt(2)
    v_mfma_f32_16x16x16_bf16 v[64:67], v[32:33], v[6:7], v[104:107]
    v_exp_f32 v72, v72 clamp
    v_exp_f32 v73, v73 clamp
    v_mfma_f32_16x16x16_bf16 v[68:71], v[36:37], v[6:7], v[104:107]
    v_exp_f32 v74, v74 clamp
    v_exp_f32 v75, v75 clamp
    v_mfma_f32_16x16x16_bf16 v[80:83], v[34:35], v[6:7], 0
    v_exp_f32 v76, v76 clamp
    v_exp_f32 v77, v77 clamp
    v_mfma_f32_16x16x16_bf16 v[84:87], v[38:39], v[6:7], 0
    v_exp_f32 v78, v78 clamp
    v_exp_f32 v79, v79 clamp
    s_waitcnt lgkmcnt(0)
    buffer_load_dwordx4 v[32:35], v[116:117], s[32:35], 0 idxen offen sc1
    buffer_load_dwordx4 v[36:39], v[118:119], s[32:35], 0 idxen offen sc1
    ds_read_u16 v116, v120 offset:28
    ds_read_u16 v118, v120 offset:30
    v_pk_fma_f32 v[72:73], v[72:73], s[60:61], s[60:61] op_sel:[0,0,1] op_sel_hi:[1,0,1]
    v_pk_fma_f32 v[74:75], v[74:75], s[60:61], s[60:61] op_sel:[0,0,1] op_sel_hi:[1,0,1]
    v_pk_fma_f32 v[76:77], v[76:77], s[60:61], s[60:61] op_sel:[0,0,1] op_sel_hi:[1,0,1]
    v_pk_fma_f32 v[78:79], v[78:79], s[60:61], s[60:61] op_sel:[0,0,1] op_sel_hi:[1,0,1]
    s_sub_u32 s55, s55, 1
    v_pk_mul_f32 v[88:89], v[56:57], v[88:89]
    v_pk_mul_f32 v[90:91], v[58:59], v[90:91]
    v_pk_fma_f32 v[48:49], v[48:49], v[72:73], v[56:57]
    v_pk_fma_f32 v[50:51], v[50:51], v[74:75], v[58:59]
    v_pk_mul_f32 v[56:57], v[56:57], v[72:73]
    v_pk_mul_f32 v[58:59], v[58:59], v[74:75]
    v_pk_fma_f32 v[52:53], v[52:53], v[72:73], v[88:89]
    v_pk_fma_f32 v[54:55], v[54:55], v[74:75], v[90:91]
    v_pk_mul_f32 v[92:93], v[56:57], v[92:93]
    v_pk_mul_f32 v[94:95], v[58:59], v[94:95]
    v_pk_fma_f32 v[48:49], v[48:49], v[76:77], v[56:57]
    v_pk_fma_f32 v[50:51], v[50:51], v[78:79], v[58:59]
    v_pk_mul_f32 v[56:57], v[56:57], v[76:77]
    v_pk_mul_f32 v[58:59], v[58:59], v[78:79]
    v_pk_fma_f32 v[52:53], v[52:53], v[76:77], v[92:93]
    v_pk_fma_f32 v[54:55], v[54:55], v[78:79], v[94:95]
    v_mfma_f32_4x4x4_16b_bf16 v[64:67], v[4:5], v[96:97], v[64:67]
    v_rcp_f32 v56, v56
    v_mfma_f32_4x4x4_16b_bf16 v[68:71], v[4:5], v[98:99], v[68:71]
    v_rcp_f32 v57, v57
    v_mfma_f32_4x4x4_16b_bf16 v[72:75], v[4:5], v[100:101], v[104:107]
    v_rcp_f32 v58, v58
    v_mfma_f32_4x4x4_16b_bf16 v[76:79], v[4:5], v[102:103], v[104:107]
    v_rcp_f32 v59, v59
    ds_read_b128 v[96:99], v27 offset:96
    v_pk_fma_f32 v[108:109], v[48:49], v[56:57], v[108:109]
    v_pk_fma_f32 v[112:113], v[52:53], v[56:57], v[112:113]
    v_pk_fma_f32 v[110:111], v[50:51], v[58:59], v[110:111]
    v_pk_fma_f32 v[114:115], v[54:55], v[58:59], v[114:115]
    v_add_u32 v27, 64, v27
    v_add_u32 v120, 16, v120
    s_cbranch_scc0 L_B0
L_T0:
    s_cmp_lg_u32 s54, 0
    s_cbranch_scc1 L_pr0
    s_setprio 0
L_pr0:
    s_waitcnt vmcnt(2)
    v_mfma_f32_16x16x16_bf16 v[72:75], v[40:41], v[6:7], v[72:75]
    v_exp_f32 v64, v64 clamp
    v_exp_f32 v65, v65 clamp
    v_mfma_f32_16x16x16_bf16 v[76:79], v[44:45], v[6:7], v[76:79]
    v_exp_f32 v66, v66 clamp
    v_exp_f32 v67, v67 clamp
    v_mfma_f32_16x16x16_bf16 v[88:91], v[42:43], v[6:7], 0
    v_exp_f32 v68, v68 clamp
    v_exp_f32 v69, v69 clamp
    v_mfma_f32_16x16x16_bf16 v[92:95], v[46:47], v[6:7], 0
    v_exp_f32 v70, v70 clamp
    v_exp_f32 v71, v71 clamp
    s_waitcnt lgkmcnt(0)
    v_pk_fma_f32 v[64:65], v[64:65], s[60:61], s[60:61] op_sel:[0,0,1] op_sel_hi:[1,0,1]
    v_pk_fma_f32 v[66:67], v[66:67], s[60:61], s[60:61] op_sel:[0,0,1] op_sel_hi:[1,0,1]
    v_pk_fma_f32 v[68:69], v[68:69], s[60:61], s[60:61] op_sel:[0,0,1] op_sel_hi:[1,0,1]
    v_pk_fma_f32 v[70:71], v[70:71], s[60:61], s[60:61] op_sel:[0,0,1] op_sel_hi:[1,0,1]
    v_pk_mul_f32 v[52:53], v[64:65], v[84:85]
    v_pk_mul_f32 v[54:55], v[66:67], v[86:87]
    v_pk_mul_f32 v[56:57], v[64:65], v[68:69]
    v_pk_mul_f32 v[58:59], v[66:67], v[70:71]
    v_pk_fma_f32 v[52:53], v[68:69], v[80:81], v[52:53]
    v_pk_fma_f32 v[54:55], v[70:71], v[82:83], v[54:55]
    v_pk_add_f32 v[48:49], v[64:65], v[68:69]
    v_pk_add_f32 v[50:51], v[66:67], v[70:71]
    s_waitcnt vmcnt(0)
    v_mfma_f32_16x16x16_bf16 v[64:67], v[32:33], v[6:7], v[104:107]
    v_exp_f32 v72, v72 clamp
    v_exp_f32 v73, v73 clamp
    v_mfma_f32_16x16x16_bf16 v[68:71], v[36:37], v[6:7], v[104:107]
    v_exp_f32 v74, v74 clamp
    v_exp_f32 v75, v75 clamp
    v_mfma_f32_16x16x16_bf16 v[80:83], v[34:35], v[6:7], 0
    v_exp_f32 v76, v76 clamp
    v_exp_f32 v77, v77 clamp
    v_mfma_f32_16x16x16_bf16 v[84:87], v[38:39], v[6:7], 0
    v_exp_f32 v78, v78 clamp
    v_exp_f32 v79, v79 clamp
    ds_read_b128 v[104:107], v26 offset:19968
    v_pk_fma_f32 v[72:73], v[72:73], s[60:61], s[60:61] op_sel:[0,0,1] op_sel_hi:[1,0,1]
    v_pk_fma_f32 v[74:75], v[74:75], s[60:61], s[60:61] op_sel:[0,0,1] op_sel_hi:[1,0,1]
    v_pk_fma_f32 v[76:77], v[76:77], s[60:61], s[60:61] op_sel:[0,0,1] op_sel_hi:[1,0,1]
    v_pk_fma_f32 v[78:79], v[78:79], s[60:61], s[60:61] op_sel:[0,0,1] op_sel_hi:[1,0,1]
    v_pk_mul_f32 v[88:89], v[56:57], v[88:89]
    v_pk_mul_f32 v[90:91], v[58:59], v[90:91]
    v_pk_fma_f32 v[48:49], v[48:49], v[72:73], v[56:57]
    v_pk_fma_f32 v[50:51], v[50:51], v[74:75], v[58:59]
    v_pk_mul_f32 v[56:57], v[56:57], v[72:73]
    v_pk_mul_f32 v[58:59], v[58:59], v[74:75]
    v_pk_fma_f32 v[52:53], v[52:53], v[72:73], v[88:89]
    v_pk_fma_f32 v[54:55], v[54:55], v[74:75], v[90:91]
    v_pk_mul_f32 v[92:93], v[56:57], v[92:93]
    v_pk_mul_f32 v[94:95], v[58:59], v[94:95]
    v_pk_fma_f32 v[48:49], v[48:49], v[76:77], v[56:57]
    v_pk_fma_f32 v[50:51], v[50:51], v[78:79], v[58:59]
    v_pk_mul_f32 v[56:57], v[56:57], v[76:77]
    v_pk_mul_f32 v[58:59], v[58:59], v[78:79]
    v_pk_fma_f32 v[52:53], v[52:53], v[76:77], v[92:93]
    v_pk_fma_f32 v[54:55], v[54:55], v[78:79], v[94:95]
    v_mfma_f32_4x4x4_16b_bf16 v[64:67], v[4:5], v[96:97], v[64:67]
    v_rcp_f32 v56, v56
    v_rcp_f32 v57, v57
    v_mfma_f32_4x4x4_16b_bf16 v[68:71], v[4:5], v[98:99], v[68:71]
    v_rcp_f32 v58, v58
    v_rcp_f32 v59, v59
    v_pk_fma_f32 v[108:109], v[48:49], v[56:57], v[108:109]
    v_pk_fma_f32 v[112:113], v[52:53], v[56:57], v[112:113]
    v_pk_fma_f32 v[110:111], v[50:51], v[58:59], v[110:111]
    v_pk_fma_f32 v[114:115], v[54:55], v[58:59], v[114:115]
    s_bitcmp1_b32 s82, 0
    s_cbranch_scc1 L_H0
    v_exp_f32 v64, v64 clamp
    v_exp_f32 v65, v65 clamp
    v_exp_f32 v66, v66 clamp
    v_exp_f32 v67, v67 clamp
    v_exp_f32 v68, v68 clamp
    v_exp_f32 v69, v69 clamp
    v_exp_f32 v70, v70 clamp
    v_exp_f32 v71, v71 clamp
    v_pk_fma_f32 v[64:65], v[64:65], s[60:61], s[60:61] op_sel:[0,0,1] op_sel_hi:[1,0,1]
    v_pk_fma_f32 v[66:67], v[66:67], s[60:61], s[60:61] op_sel:[0,0,1] op_sel_hi:[1,0,1]
    v_pk_fma_f32 v[68:69], v[68:69], s[60:61], s[60:61] op_sel:[0,0,1] op_sel_hi:[1,0,1]
    v_pk_fma_f32 v[70:71], v[70:71], s[60:61], s[60:61] op_sel:[0,0,1] op_sel_hi:[1,0,1]
    v_pk_fma_f32 v[108:109], v[108:109], v[64:65], 1.0 op_sel_hi:[1,1,0]
    v_pk_fma_f32 v[110:111], v[110:111], v[66:67], 1.0 op_sel_hi:[1,1,0]
    v_pk_fma_f32 v[112:113], v[112:113], v[64:65], v[80:81]
    v_pk_fma_f32 v[114:115], v[114:115], v[66:67], v[82:83]
    v_pk_mul_f32 v[84:85], v[64:65], v[84:85]
    v_pk_mul_f32 v[86:87], v[66:67], v[86:87]
    v_pk_fma_f32 v[108:109], v[108:109], v[68:69], v[64:65]
    v_pk_fma_f32 v[110:111], v[110:111], v[70:71], v[66:67]
    v_pk_fma_f32 v[112:113], v[112:113], v[68:69], v[84:85]
    v_pk_fma_f32 v[114:115], v[114:115], v[70:71], v[86:87]
L_epi:
    v_rcp_f32 v108, v108
    v_rcp_f32 v109, v109
    v_rcp_f32 v110, v110
    v_rcp_f32 v111, v111
    s_waitcnt lgkmcnt(0)
    v_pk_fma_f32 v[104:105], v[112:113], v[108:109], v[104:105]
    v_pk_fma_f32 v[106:107], v[114:115], v[110:111], v[106:107]
    v_max_f32 v104, 0, v104
    v_max_f32 v105, 0, v105
    v_max_f32 v106, 0, v106
    v_max_f32 v107, 0, v107
    ds_write_b128 v26, v[104:107] offset:19968
    ds_read_b128 v[104:107], v122 offset:19968
    s_waitcnt lgkmcnt(0)
    v_mfma_f32_4x4x4_16b_bf16 v[104:107], v[24:25], v[28:29], v[104:107]
    s_mov_b32 s53, s54
    s_mov_b32 s54, 0
    s_cmp_eq_u32 s53, 0
    s_nop 1
    v_cvt_pk_bf16_f32 v96, v104, v105
    v_cvt_pk_bf16_f32 v97, v106, v107
    buffer_store_dwordx2 v[96:97], v123, s[36:39], 0 offen sc1 nt
    s_cbranch_scc1 L_fin
    v_add_u32 v2, s53, v124
    v_add_u32 v3, s53, v125
    v_mov_b32 v108, 0x438637bd
    v_mov_b32 v112, 0
    v_mov_b32 v109, 0x438637bd
    v_mov_b32 v113, 0
    v_mov_b32 v110, 0x438637bd
    v_mov_b32 v114, 0
    v_mov_b32 v111, 0x438637bd
    v_mov_b32 v115, 0
    s_branch L_grp
L_fin:
    s_endpgm
L_T1:
    s_cmp_lg_u32 s54, 0
    s_cbranch_scc1 L_pr1
    s_setprio 0
L_pr1:
    s_waitcnt vmcnt(2)
    v_mfma_f32_16x16x16_bf16 v[64:67], v[32:33], v[6:7], v[104:107]
    v_exp_f32 v72, v72 clamp
    v_exp_f32 v73, v73 clamp
    v_mfma_f32_16x16x16_bf16 v[68:71], v[36:37], v[6:7], v[104:107]
    v_exp_f32 v74, v74 clamp
    v_exp_f32 v75, v75 clamp
    v_mfma_f32_16x16x16_bf16 v[80:83], v[34:35], v[6:7], 0
    v_exp_f32 v76, v76 clamp
    v_exp_f32 v77, v77 clamp
    v_mfma_f32_16x16x16_bf16 v[84:87], v[38:39], v[6:7], 0
    v_exp_f32 v78, v78 clamp
    v_exp_f32 v79, v79 clamp
    s_waitcnt lgkmcnt(0)
    v_pk_fma_f32 v[72:73], v[72:73], s[60:61], s[60:61] op_sel:[0,0,1] op_sel_hi:[1,0,1]
    v_pk_fma_f32 v[74:75], v[74:75], s[60:61], s[60:61] op_sel:[0,0,1] op_sel_hi:[1,0,1]
    v_pk_fma_f32 v[76:77], v[76:77], s[60:61], s[60:61] op_sel:[0,0,1] op_sel_hi:[1,0,1]
    v_pk_fma_f32 v[78:79], v[78:79], s[60:61], s[60:61] op_sel:[0,0,1] op_sel_hi:[1,0,1]
    v_pk_mul_f32 v[88:89], v[56:57], v[88:89]
    v_pk_mul_f32 v[90:91], v[58:59], v[90:91]
    v_pk_fma_f32 v[48:49], v[48:49], v[72:73], v[56:57]
    v_pk_fma_f32 v[50:51], v[50:51], v[74:75], v[58:59]
    v_pk_mul_f32 v[56:57], v[56:57], v[72:73]
    v_pk_mul_f32 v[58:59], v[58:59], v[74:75]
    v_pk_fma_f32 v[52:53], v[52:53], v[72:73], v[88:89]
    v_pk_fma_f32 v[54:55], v[54:55], v[74:75], v[90:91]
    v_pk_mul_f32 v[92:93], v[56:57], v[92:93]
    v_pk_mul_f32 v[94:95], v[58:59], v[94:95]
    v_pk_fma_f32 v[48:49], v[48:49], v[76:77], v[56:57]
    v_pk_fma_f32 v[50:51], v[50:51], v[78:79], v[58:59]
    v_pk_mul_f32 v[56:57], v[56:57], v[76:77]
    v_pk_mul_f32 v[58:59], v[58:59], v[78:79]
    v_pk_fma_f32 v[52:53], v[52:53], v[76:77], v[92:93]
    v_pk_fma_f32 v[54:55], v[54:55], v[78:79], v[94:95]
    v_mfma_f32_4x4x4_16b_bf16 v[64:67], v[4:5], v[96:97], v[64:67]
    v_rcp_f32 v56, v56
    v_mfma_f32_4x4x4_16b_bf16 v[68:71], v[4:5], v[98:99], v[68:71]
    v_rcp_f32 v57, v57
    v_mfma_f32_4x4x4_16b_bf16 v[72:75], v[4:5], v[100:101], v[104:107]
    v_rcp_f32 v58, v58
    v_mfma_f32_4x4x4_16b_bf16 v[76:79], v[4:5], v[102:103], v[104:107]
    v_rcp_f32 v59, v59
    v_pk_fma_f32 v[108:109], v[48:49], v[56:57], v[108:109]
    v_pk_fma_f32 v[112:113], v[52:53], v[56:57], v[112:113]
    v_pk_fma_f32 v[110:111], v[50:51], v[58:59], v[110:111]
    v_pk_fma_f32 v[114:115], v[54:55], v[58:59], v[114:115]
    s_waitcnt vmcnt(0)
    v_mfma_f32_16x16x16_bf16 v[72:75], v[40:41], v[6:7], v[72:75]
    v_exp_f32 v64, v64 clamp
    v_exp_f32 v65, v65 clamp
    v_mfma_f32_16x16x16_bf16 v[76:79], v[44:45], v[6:7], v[76:79]
    v_exp_f32 v66, v66 clamp
    v_exp_f32 v67, v67 clamp
    v_mfma_f32_16x16x16_bf16 v[88:91], v[42:43], v[6:7], 0
    v_exp_f32 v68, v68 clamp
    v_exp_f32 v69, v69 clamp
    v_mfma_f32_16x16x16_bf16 v[92:95], v[46:47], v[6:7], 0
    v_exp_f32 v70, v70 clamp
    v_exp_f32 v71, v71 clamp
    ds_read_b128 v[104:107], v26 offset:19968
    v_pk_fma_f32 v[64:65], v[64:65], s[60:61], s[60:61] op_sel:[0,0,1] op_sel_hi:[1,0,1]
    v_pk_fma_f32 v[66:67], v[66:67], s[60:61], s[60:61] op_sel:[0,0,1] op_sel_hi:[1,0,1]
    v_pk_fma_f32 v[68:69], v[68:69], s[60:61], s[60:61] op_sel:[0,0,1] op_sel_hi:[1,0,1]
    v_pk_fma_f32 v[70:71], v[70:71], s[60:61], s[60:61] op_sel:[0,0,1] op_sel_hi:[1,0,1]
    v_pk_fma_f32 v[108:109], v[108:109], v[64:65], 1.0 op_sel_hi:[1,1,0]
    v_pk_fma_f32 v[110:111], v[110:111], v[66:67], 1.0 op_sel_hi:[1,1,0]
    v_pk_fma_f32 v[112:113], v[112:113], v[64:65], v[80:81]
    v_pk_fma_f32 v[114:115], v[114:115], v[66:67], v[82:83]
    v_pk_mul_f32 v[84:85], v[64:65], v[84:85]
    v_pk_mul_f32 v[86:87], v[66:67], v[86:87]
    v_pk_fma_f32 v[108:109], v[108:109], v[68:69], v[64:65]
    v_pk_fma_f32 v[110:111], v[110:111], v[70:71], v[66:67]
    v_pk_fma_f32 v[112:113], v[112:113], v[68:69], v[84:85]
    v_pk_fma_f32 v[114:115], v[114:115], v[70:71], v[86:87]
    v_pk_mul_f32 v[56:57], v[64:65], v[68:69]
    v_pk_mul_f32 v[58:59], v[66:67], v[70:71]
    s_bitcmp1_b32 s82, 0
    s_cbranch_scc1 L_H1
    v_exp_f32 v72, v72 clamp
    v_exp_f32 v73, v73 clamp
    v_exp_f32 v74, v74 clamp
    v_exp_f32 v75, v75 clamp
    v_exp_f32 v76, v76 clamp
    v_exp_f32 v77, v77 clamp
    v_exp_f32 v78, v78 clamp
    v_exp_f32 v79, v79 clamp
    v_pk_fma_f32 v[72:73], v[72:73], s[60:61], s[60:61] op_sel:[0,0,1] op_sel_hi:[1,0,1]
    v_pk_fma_f32 v[74:75], v[74:75], s[60:61], s[60:61] op_sel:[0,0,1] op_sel_hi:[1,0,1]
    v_pk_fma_f32 v[76:77], v[76:77], s[60:61], s[60:61] op_sel:[0,0,1] op_sel_hi:[1,0,1]
    v_pk_fma_f32 v[78:79], v[78:79], s[60:61], s[60:61] op_sel:[0,0,1] op_sel_hi:[1,0,1]
    v_pk_mul_f32 v[88:89], v[56:57], v[88:89]
    v_pk_mul_f32 v[90:91], v[58:59], v[90:91]
    v_pk_fma_f32 v[108:109], v[108:109], v[72:73], v[56:57]
    v_pk_fma_f32 v[110:111], v[110:111], v[74:75], v[58:59]
    v_pk_mul_f32 v[56:57], v[56:57], v[72:73]
    v_pk_mul_f32 v[58:59], v[58:59], v[74:75]
    v_pk_fma_f32 v[112:113], v[112:113], v[72:73], v[88:89]
    v_pk_fma_f32 v[114:115], v[114:115], v[74:75], v[90:91]
    v_pk_mul_f32 v[92:93], v[56:57], v[92:93]
    v_pk_mul_f32 v[94:95], v[58:59], v[94:95]
    v_pk_fma_f32 v[108:109], v[108:109], v[76:77], v[56:57]
    v_pk_fma_f32 v[110:111], v[110:111], v[78:79], v[58:59]
    v_pk_fma_f32 v[112:113], v[112:113], v[76:77], v[92:93]
    v_pk_fma_f32 v[114:115], v[114:115], v[78:79], v[94:95]
    s_branch L_epi
L_H1:
    v_exp_f32 v72, v72 clamp
    v_exp_f32 v73, v73 clamp
    v_exp_f32 v74, v74 clamp
    v_exp_f32 v75, v75 clamp
    v_pk_fma_f32 v[72:73], v[72:73], s[60:61], s[60:61] op_sel:[0,0,1] op_sel_hi:[1,0,1]
    v_pk_fma_f32 v[74:75], v[74:75], s[60:61], s[60:61] op_sel:[0,0,1] op_sel_hi:[1,0,1]
    v_pk_mul_f32 v[88:89], v[56:57], v[88:89]
    v_pk_mul_f32 v[90:91], v[58:59], v[90:91]
    v_pk_fma_f32 v[108:109], v[108:109], v[72:73], v[56:57]
    v_pk_fma_f32 v[110:111], v[110:111], v[74:75], v[58:59]
    v_pk_fma_f32 v[112:113], v[112:113], v[72:73], v[88:89]
    v_pk_fma_f32 v[114:115], v[114:115], v[74:75], v[90:91]
    s_branch L_epi
L_H0:
    v_exp_f32 v64, v64 clamp
    v_exp_f32 v65, v65 clamp
    v_exp_f32 v66, v66 clamp
    v_exp_f32 v67, v67 clamp
    v_pk_fma_f32 v[64:65], v[64:65], s[60:61], s[60:61] op_sel:[0,0,1] op_sel_hi:[1,0,1]
    v_pk_fma_f32 v[66:67], v[66:67], s[60:61], s[60:61] op_sel:[0,0,1] op_sel_hi:[1,0,1]
    v_pk_fma_f32 v[108:109], v[108:109], v[64:65], 1.0 op_sel_hi:[1,1,0]
    v_pk_fma_f32 v[110:111], v[110:111], v[66:67], 1.0 op_sel_hi:[1,1,0]
    v_pk_fma_f32 v[112:113], v[112:113], v[64:65], v[80:81]
    v_pk_fma_f32 v[114:115], v[114:115], v[66:67], v[82:83]
    s_branch L_epi
L_P2:
    s_cmp_eq_u32 s26, 5
    s_cbranch_scc1 L_Q2
    v_lshlrev_b32 v64, 7, v1
    s_lshl_b32 s57, s27, 13
    s_add_u32 s44, s24, 7995392
    s_addc_u32 s45, s25, 0
    s_mov_b32 s46, 32768
    s_mov_b32 s47, 0x00020000
L_P2a:
    ds_read_b32 v65, v60 offset:24
L_P2a_w:
    s_waitcnt lgkmcnt(0)
    v_cmp_ne_u32 vcc, 10, v65
    s_cbranch_vccz L_P2a_d
    s_sub_u32 s31, s31, 1
    s_cbranch_scc0 L_P2a
    s_endpgm
L_P2a_d:
L_P3:
    buffer_load_dword v65, v64, s[44:47], s57 offen sc1
L_P3_w:
    s_waitcnt vmcnt(0)
    v_cmp_ne_u32 vcc, s52, v65
    s_and_b64 exec, exec, vcc
    s_cbranch_scc0 L_P3_d
    s_sub_u32 s31, s31, 16
    s_cbranch_scc0 L_P3
    s_endpgm
L_P3_d:
    s_mov_b64 exec, -1
    s_branch L_bar
L_Q2:
L_Q3:
    ds_read_b32 v94, v60 offset:20
    ds_read_b32 v80, v64 offset:1792
    ds_read_b32 v81, v64 offset:2048
    ds_read_b32 v82, v64 offset:2304
L_Q3_w:
    s_waitcnt lgkmcnt(0)
    v_cmp_ne_u32 vcc, 16, v94
    s_cbranch_vccz L_Q3_d
    s_sub_u32 s31, s31, 1
    s_cbranch_scc0 L_Q3
    s_endpgm
L_Q3_d:
    v_sub_u32 v80, v80, v91
    v_min_u32 v80, 0x7e, v80
    v_lshlrev_b32 v83, 1, v80
    v_xor_b32 v83, 0xfc, v83
    ds_add_rtn_u32 v86, v83, v61 offset:512
    v_sub_u32 v81, v81, v92
    v_min_u32 v81, 0x7e, v81
    v_lshlrev_b32 v84, 1, v81
    v_xor_b32 v84, 0xfc, v84
    ds_add_rtn_u32 v87, v84, v61 offset:512
    v_sub_u32 v82, v82, v93
    v_min_u32 v82, 0x7e, v82
    v_lshlrev_b32 v85, 1, v82
    v_xor_b32 v85, 0xfc, v85
    s_mov_b32 exec_hi, 0
    ds_add_rtn_u32 v88, v85, v61 offset:512
    s_mov_b32 exec_hi, -1
    ds_read_b32 v89, v64 offset:512
    v_lshrrev_b32 v69, 1, v80
    v_lshrrev_b32 v73, 1, v81
    v_lshrrev_b32 v77, 1, v82
    s_waitcnt lgkmcnt(0)
    v_add_u32_dpp v90, v89, v89 row_shr:1 row_mask:0xf bank_mask:0xf bound_ctrl:0
    s_nop 1
    v_add_u32_dpp v90, v90, v90 row_shr:2 row_mask:0xf bank_mask:0xf bound_ctrl:0
    s_nop 1
    v_add_u32_dpp v90, v90, v90 row_shr:4 row_mask:0xf bank_mask:0xf bound_ctrl:0
    s_nop 1
    v_add_u32_dpp v90, v90, v90 row_shr:8 row_mask:0xf bank_mask:0xf bound_ctrl:0
    s_nop 1
    v_add_u32_dpp v90, v90, v90 row_bcast:15 row_mask:0xa bank_mask:0xf
    s_nop 1
    v_add_u32_dpp v90, v90, v90 row_bcast:31 row_mask:0xc bank_mask:0xf
    v_sub_u32 v90, v90, v89
    ds_bpermute_b32 v83, v83, v90
    ds_bpermute_b32 v84, v84, v90
    ds_bpermute_b32 v85, v85, v90
    s_waitcnt lgkmcnt(2)
    v_add_lshl_u32 v83, v83, v86, 4
    ds_write_b128 v83, v[68:71] offset:3584
    s_waitcnt lgkmcnt(2)
    v_add_lshl_u32 v84, v84, v87, 4
    ds_write_b128 v84, v[72:75] offset:3584
    s_waitcnt lgkmcnt(2)
    v_add_lshl_u32 v85, v85, v88, 4
    s_mov_b32 exec_hi, 0
    ds_write_b128 v85, v[76:79] offset:3584
    s_cmp_lg_u32 s2, 0
    s_cbranch_scc1 L_bar
    v_mov_b32 v94, s75
    v_mov_b32 v89, s52
    s_mov_b64 exec, 1
    global_store_dword v94, v89, s[24:25] sc1
    s_branch L_bar
L_Drem:
    s_mov_b64 s[76:77], exec
    s_mov_b64 exec, -1
    v_lshlrev_b32 v52, 4, v1
L_Dr1:
    s_ff1_i32_b64 s57, s[76:77]
    s_bitset0_b64 s[76:77], s57
    v_readlane_b32 s78, v63, s57
    v_readlane_b32 s79, v62, s57
    s_bfe_u32 s79, s79, 0xa0012
    s_sub_u32 s79, s79, 27
L_Dr2:
    v_cmp_gt_u32 vcc, s79, v1
    s_mov_b64 exec, vcc
    buffer_load_dwordx4 v[26:29], v52, s[48:51], s78 offen offset:432 sc1
    s_waitcnt vmcnt(0) lgkmcnt(0)
L_Dr3:
    v_cmp_ne_u32 vcc, s52, v29
    s_cbranch_vccnz L_Dr3_r
    v_and_b32_sdwa v29, s72, v28 dst_sel:DWORD dst_unused:UNUSED_PAD src0_sel:DWORD src1_sel:WORD_1
    ds_add_rtn_u32 v29, v29, v59 offset:1792
    s_waitcnt lgkmcnt(0)
    v_min_u32 v29, s73, v29
    v_lshlrev_b32 v53, 2, v29
    ds_write_b16 v29, v28 offset:7168
    ds_write_b64 v53, v[26:27] offset:60928
    s_waitcnt lgkmcnt(0)
    s_mov_b64 exec, -1
    s_add_u32 s78, s78, 1024
    s_sub_u32 s79, s79, 64
    s_cmp_gt_i32 s79, 0
    s_cbranch_scc1 L_Dr2
    s_cmp_lg_u64 s[76:77], 0
    s_cbranch_scc1 L_Dr1
    s_branch L_D4
L_C0_r:
    s_sub_u32 s31, s31, 16
    s_cbranch_scc1 L_end
    buffer_load_dwordx4 v[64:67], v63, s[48:51], 0 offen offset:256 sc1
    s_waitcnt vmcnt(0)
    s_branch L_C0
L_C1_r:
    s_sub_u32 s31, s31, 16
    s_cbranch_scc1 L_end
    buffer_load_dwordx4 v[68:71], v63, s[48:51], 0 offen offset:272 sc1
    s_waitcnt vmcnt(0)
    s_branch L_C1
L_C2_r:
    s_sub_u32 s31, s31, 16
    s_cbranch_scc1 L_end
    buffer_load_dwordx4 v[72:75], v63, s[48:51], 0 offen offset:288 sc1
    s_waitcnt vmcnt(0)
    s_branch L_C2
L_C3_r:
    s_sub_u32 s31, s31, 16
    s_cbranch_scc1 L_end
    buffer_load_dwordx4 v[76:79], v63, s[48:51], 0 offen offset:304 sc1
    s_waitcnt vmcnt(0)
    s_branch L_C3
L_C4_r:
    s_sub_u32 s31, s31, 16
    s_cbranch_scc1 L_end
    buffer_load_dwordx4 v[80:83], v63, s[48:51], 0 offen offset:320 sc1
    s_waitcnt vmcnt(0)
    s_branch L_C4
L_C5_r:
    s_sub_u32 s31, s31, 16
    s_cbranch_scc1 L_end
    buffer_load_dwordx4 v[84:87], v63, s[48:51], 0 offen offset:336 sc1
    s_waitcnt vmcnt(0)
    s_branch L_C5
L_C6_r:
    s_sub_u32 s31, s31, 16
    s_cbranch_scc1 L_end
    buffer_load_dwordx4 v[88:91], v63, s[48:51], 0 offen offset:352 sc1
    s_waitcnt vmcnt(0)
    s_branch L_C6
L_C7_r:
    s_sub_u32 s31, s31, 16
    s_cbranch_scc1 L_end
    buffer_load_dwordx4 v[92:95], v63, s[48:51], 0 offen offset:368 sc1
    s_waitcnt vmcnt(0)
    s_branch L_C7
L_C8_r:
    s_sub_u32 s31, s31, 16
    s_cbranch_scc1 L_end
    buffer_load_dwordx4 v[96:99], v63, s[48:51], 0 offen offset:384 sc1
    s_waitcnt vmcnt(0)
    s_branch L_C8
L_C9_r:
    s_sub_u32 s31, s31, 16
    s_cbranch_scc1 L_end
    buffer_load_dwordx4 v[100:103], v63, s[48:51], 0 offen offset:400 sc1
    s_waitcnt vmcnt(0)
    s_branch L_C9
L_C10_r:
    s_sub_u32 s31, s31, 16
    s_cbranch_scc1 L_end
    buffer_load_dwordx4 v[104:107], v63, s[48:51], 0 offen offset:416 sc1
    s_waitcnt vmcnt(0)
    s_branch L_C10
L_R0_r:
    s_sub_u32 s31, s31, 16
    s_cbranch_scc1 L_end
    buffer_load_dwordx4 v[32:35], v48, s[48:51], 0 offen sc1
    s_waitcnt vmcnt(0)
    s_branch L_R0
L_R1_r:
    s_sub_u32 s31, s31, 16
    s_cbranch_scc1 L_end
    buffer_load_dwordx4 v[36:39], v49, s[48:51], 0 offen sc1
    s_waitcnt vmcnt(0)
    s_branch L_R1
L_R2_r:
    s_sub_u32 s31, s31, 16
    s_cbranch_scc1 L_end
    buffer_load_dwordx4 v[40:43], v50, s[48:51], 0 offen sc1
    s_waitcnt vmcnt(0)
    s_branch L_R2
L_R3_r:
    s_sub_u32 s31, s31, 16
    s_cbranch_scc1 L_end
    buffer_load_dwordx4 v[44:47], v51, s[48:51], 0 offen sc1
    s_waitcnt vmcnt(0)
    s_branch L_R3
L_Dr3_r:
    s_sub_u32 s31, s31, 16
    s_cbranch_scc1 L_end
    buffer_load_dwordx4 v[26:29], v52, s[48:51], s78 offen offset:432 sc1
    s_waitcnt vmcnt(0)
    s_branch L_Dr3
L_slow:
    s_waitcnt vmcnt(0) lgkmcnt(0)
    v_lshlrev_b32 v2, 2, v0
    v_add_u32 v2, 60928, v2
    v_mov_b32 v3, 0x498637bd
    v_mov_b32 v4, 0
    ds_write_b32 v2, v3 offset:0
    ds_write_b32 v2, v4 offset:20480
    ds_write_b32 v2, v3 offset:4096
    ds_write_b32 v2, v4 offset:24576
    ds_write_b32 v2, v3 offset:8192
    ds_write_b32 v2, v4 offset:28672
    ds_write_b32 v2, v3 offset:12288
    ds_write_b32 v2, v4 offset:32768
    ds_write_b32 v2, v3 offset:16384
    ds_write_b32 v2, v4 offset:36864
    v_and_b32 v36, 31, v1
    s_lshl_b32 s57, s27, 6
    v_lshl_add_u32 v41, v36, 1, s57
    global_load_ushort v32, v41, s[16:17]
    global_load_ushort v33, v41, s[16:17] offset:256
    global_load_ushort v34, v41, s[16:17] offset:512
    global_load_ushort v35, v41, s[16:17] offset:768
    s_lshl_b32 s57, s26, 6
    v_and_b32 v2, 15, v1
    v_lshl_add_u32 v2, v2, 2, s57
    ds_read_b32 v42, v2 offset:6144
    v_lshlrev_b32 v40, 2, v36
    v_and_b32 v37, 12, v40
    v_and_b32 v39, 0x70, v40
    v_lshrrev_b32 v36, 2, v36
    v_add_u32 v40, 60928, v40
    v_and_b32 v39, 64, v39
    v_lshl_add_u32 v39, v37, 2, v39
    v_and_b32 v2, 2, v36
    v_lshl_add_u32 v39, v2, 1, v39
    v_and_b32 v43, 1, v36
    v_xor_b32 v43, 1, v43
    v_lshlrev_b32 v43, 4, v43
    v_lshrrev_b32 v54, 5, v1
    v_lshlrev_b32 v55, 4, v54
    s_waitcnt vmcnt(0) lgkmcnt(0)
    v_lshlrev_b32 v32, 16, v32
    v_mul_f32 v32, 0xbfb8aa3b, v32
    v_lshlrev_b32 v33, 16, v33
    v_mul_f32 v33, 0xbfb8aa3b, v33
    v_lshlrev_b32 v34, 16, v34
    v_mul_f32 v34, 0xbfb8aa3b, v34
    v_lshlrev_b32 v35, 16, v35
    v_mul_f32 v35, 0xbfb8aa3b, v35
    s_barrier
    s_mov_b32 s64, 0
L_s_cell:
    v_readlane_b32 s65, v42, s64
    s_and_b32 s57, s65, 0x3ffff
    s_lshl_b32 s57, s57, 4
    s_bfe_u32 s65, s65, 0xa0012
L_s_rec:
    s_cmp_lt_i32 s65, 1
    s_cbranch_scc1 L_s_next
    v_cmp_gt_u32 vcc, s65, v54
    s_mov_b64 exec, vcc
    buffer_load_dwordx3 v[44:46], v55, s[48:51], s57 offen sc1
    s_sub_u32 s65, s65, 2
    s_add_u32 s57, s57, 32
    s_waitcnt vmcnt(0)
    v_and_b32 v38, 0xffff, v46
    buffer_load_dword v47, v[38:39], s[32:35], 0 idxen offen sc1
    buffer_load_dword v48, v[38:39], s[32:35], 0 idxen offen offset:8 sc1
    v_lshrrev_b32 v46, 18, v46
    v_xor_b32 v2, v36, v46
    v_and_b32 v2, 15, v2
    v_lshl_add_u32 v2, v2, 4, v37
    v_lshl_add_u32 v2, v46, 8, v2
    ds_read_b32 v49, v2 offset:19968
    v_lshl_add_u32 v3, v46, 7, v40
    v_lshlrev_b32 v50, 16, v44
    v_and_b32 v51, 0xffff0000, v44
    v_lshlrev_b32 v52, 16, v45
    v_and_b32 v53, 0xffff0000, v45
    s_waitcnt vmcnt(0) lgkmcnt(0)
    v_fmac_f32 v49, v50, v32
    v_fmac_f32 v49, v51, v33
    v_fmac_f32 v49, v52, v34
    v_fmac_f32 v49, v53, v35
    v_lshlrev_b32 v47, v43, v47
    v_lshlrev_b32 v48, v43, v48
    v_and_b32 v47, 0xffff0000, v47
    v_and_b32 v48, 0xffff0000, v48
    v_add_f32 v49, v49, v47
    v_exp_f32 v49, v49 clamp
    s_nop 0
    v_add_f32 v49, 0x2b800000, v49
    v_rcp_f32 v49, v49
    s_nop 0
    v_mul_f32 v48, v48, v49
    ds_add_f32 v3, v49
    ds_add_f32 v3, v48 offset:20480
    s_mov_b64 exec, -1
    s_branch L_s_rec
L_s_next:
    s_add_u32 s64, s64, 1
    s_cmp_lt_u32 s64, 16
    s_cbranch_scc1 L_s_cell
    s_waitcnt lgkmcnt(0)
    s_barrier
    s_lshl_b32 s64, s26, 1
L_s_out:
    v_add_u32 v46, s64, v54
    v_xor_b32 v2, v36, v46
    v_xor_b32 v2, 8, v2
    v_and_b32 v2, 15, v2
    v_lshl_add_u32 v2, v2, 4, v37
    v_lshl_add_u32 v2, v46, 8, v2
    ds_read_b32 v49, v2 offset:19968
    v_lshl_add_u32 v3, v46, 7, v40
    ds_read_b32 v50, v3
    ds_read_b32 v51, v3 offset:20480
    v_lshl_add_u32 v2, v46, 8, v41
    buffer_load_ushort v52, v2, s[40:43], 0 offen
    s_waitcnt vmcnt(0) lgkmcnt(0)
    v_rcp_f32 v50, v50
    v_lshlrev_b32 v52, 16, v52
    v_fmac_f32 v49, v50, v51
    v_max_f32 v49, 0, v49
    v_add_f32 v49, v49, v52
    v_cvt_pk_bf16_f32 v49, v49, v49
    buffer_store_short v49, v2, s[36:39], 0 offen
    s_add_u32 s64, s64, 32
    s_cmp_lt_u32 s64, 160
    s_cbranch_scc1 L_s_out
L_end:
    s_endpgm
.section .rodata,"a"
.p2align 6
.amdhsa_kernel standalone__edge_featured_mpnn_gatedgcn__graph_kernel
  .amdhsa_next_free_vgpr 128
  .amdhsa_next_free_sgpr 102
  .amdhsa_accum_offset 128
  .amdhsa_group_segment_fixed_size 0
  .amdhsa_kernarg_size 96
  .amdhsa_user_sgpr_count 2
  .amdhsa_user_sgpr_kernarg_segment_ptr 1
  .amdhsa_system_sgpr_workgroup_id_x 1
.end_amdhsa_kernel
```
